```python
import torch

def _softmax(x, axis=-1):
    return torch.softmax(x, dim=axis)
def _gelu(x):
    return torch.nn.functional.gelu(x, approximate="tanh")
def _silu(x):
    return torch.nn.functional.silu(x)
def _sigmoid(x):
    return torch.sigmoid(x)
def _layernorm(x, axis=-1, eps=1e-5):
    m = x.mean(dim=axis, keepdim=True)
    v = x.var(dim=axis, keepdim=True, unbiased=False)
    return (x - m) / torch.sqrt(v + eps)
def _scatter_add(tgt, idx, src, axis=0):
    return tgt.clone().index_add_(axis, idx, src)
def _segment_sum(src, seg, n):
    out = torch.zeros((n,) + src.shape[1:], dtype=src.dtype)
    return out.index_add_(0, seg, src)
def _pad(x, pw):
    flat = tuple(v for pair in reversed(pw) for v in pair)
    return torch.nn.functional.pad(x, flat)

kernel_name = 'recurrent_scan__compressed_kv_cla__dense_activation_silu__decode'

def setup_inputs():

    _w = (lambda a: (lambda t: t.to(torch.bfloat16) if t.is_floating_point() else t)(torch.as_tensor(a)))
    def _A_setup():
        B, H, Sq, Sk, D, M = 2, 32, 1, 4096, 128, 640
        Dc = 4 * D
        return {
            "x": _w((lambda *s: torch.randn(*s, dtype=torch.bfloat16) * 0.1)(B, Sq, M)),
            "c_kv": _w((lambda *s: torch.randn(*s, dtype=torch.bfloat16) * 3.2)(B, Sk, Dc)),
            "w_q": _w((lambda *s: torch.randn(*s, dtype=torch.bfloat16) * 0.8)(M, H, D) * (M ** -0.5)),
            "w_uk": _w((lambda *s: torch.randn(*s, dtype=torch.bfloat16) * 0.8)(Dc, H, D) * (Dc ** -0.5)),
            "w_uv": _w((lambda *s: torch.randn(*s, dtype=torch.bfloat16) * 3.2)(Dc, H, D) * (Dc ** -0.5)),
            "w_o": _w((lambda *s: torch.randn(*s, dtype=torch.bfloat16) * 3.2)(H, D, M) * ((H * D) ** -0.5)),
        }
    _A_in = _A_setup()

    def _B_setup():
        B, S, D, F = 2, 1, 640, 1728
        return {
            "x": _w((lambda *s: torch.randn(*s, dtype=torch.bfloat16) * 0.1)(B, S, D)),
            "w1": _w((lambda *s: torch.randn(*s, dtype=torch.bfloat16) * 3.2)(D, F) * (D ** -0.5)),
            "w2": _w((lambda *s: torch.randn(*s, dtype=torch.bfloat16) * 3.2)(F, D) * (F ** -0.5)),
        }
    _B_in = _B_setup()

    return {
        "A_x": _A_in["x"],
        "A_c_kv": _A_in["c_kv"],
        "A_w_q": _A_in["w_q"],
        "A_w_uk": _A_in["w_uk"],
        "A_w_uv": _A_in["w_uv"],
        "A_w_o": _A_in["w_o"],
        "B_x": _B_in["x"],
        "B_w1": _B_in["w1"],
        "B_w2": _B_in["w2"],
    }

def reference(A_x, A_c_kv, A_w_q, A_w_uk, A_w_uv, A_w_o, B_x, B_w1, B_w2):
    def _A_ref(x, c_kv, w_q, w_uk, w_uv, w_o):
        B, Sq, M = x.shape[0], x.shape[1], x.shape[2]
        Sk = c_kv.shape[1]
        H, D = w_q.shape[1], w_q.shape[2]
        q = torch.einsum("bqm,mhd->bhqd", x, w_q)
        k = torch.einsum("bkc,chd->bhkd", c_kv, w_uk)
        v = torch.einsum("bkc,chd->bhkd", c_kv, w_uv)
        scores = torch.einsum("bhqd,bhkd->bhqk", q, k) * (D ** -0.5)
        off = Sk - Sq
        qi = torch.arange(Sq)[:, None]
        kj = torch.arange(Sk)[None, :]
        cmask = kj <= (qi + off)
        scores = torch.where(cmask[None, None], scores, -1e9)
        p = _softmax(scores, axis=-1)
        ctx = torch.einsum("bhqk,bhkd->bhqd", p, v)
        return torch.einsum("bhqd,hdm->bqm", ctx, w_o)

    def _B_ref(x, w1, w2):
        h = torch.einsum("bsd,df->bsf", x, w1)
        h = _silu(h)
        out = torch.einsum("bsf,fd->bsd", h, w2)
        return out

    x = A_x
    xn = _layernorm(x, axis=-1)
    s = _A_ref(xn, A_c_kv, A_w_q, A_w_uk, A_w_uv, A_w_o)
    g = _silu(_B_ref(xn, B_w1, B_w2))
    return x + s * g
```

```asm
; @launch grid=(256,1,1) block=(512,1,1) lds=163840
.amdgcn_target "amdgcn-amd-amdhsa--gfx950"
.text
.globl recurrent_scan__compressed_kv_cla__dense_activation_silu__decode_kernel
.p2align 8
.type recurrent_scan__compressed_kv_cla__dense_activation_silu__decode_kernel,@function
recurrent_scan__compressed_kv_cla__dense_activation_silu__decode_kernel:
  s_cmp_ge_u32 s2, 256
  s_cbranch_scc1 L_end
  s_cmp_ge_u32 s2, 128
  s_cbranch_scc0 L_nocpf_1
  s_getpc_b64 s[4:5]
L_pc0:
  v_lshlrev_b32 v5, 6, v0
  v_min_u32 v5, L_end-L_pc0, v5
  global_load_dword v128, v5, s[4:5]
L_nocpf_1:
  s_load_dwordx2 s[28:29], s[0:1], 0
  s_mov_b32 s30, 2560
  s_mov_b32 s31, 0x00020000
  s_load_dwordx2 s[48:49], s[0:1], 88
  s_mov_b32 s50, 268435456
  s_mov_b32 s51, 0x00020000
  v_lshrrev_b32 v4, 6, v0
  v_and_b32 v1, 63, v0
  v_readfirstlane_b32 s56, v4
  v_and_b32 v2, 15, v0
  v_lshrrev_b32 v3, 4, v1
  s_mov_b32 s62, 0
  s_mov_b32 s77, 0xffffff00
  s_mov_b32 s100, 0xcccccccc
  s_mov_b32 s101, 0xcccccccc
  s_mov_b32 s4, 0xffffffff
  s_mov_b32 s5, 0xffffffff
  s_mov_b32 s70, 0x30003
  s_mov_b32 s71, 0x30003
  s_mov_b32 s72, 0xffffffff
  s_mov_b32 s73, 0x0
  s_mov_b32 s6, 0xffff
  s_mov_b32 s7, 0x0
  s_mov_b32 s18, 0xff00ff
  s_mov_b32 s19, 0xff00ff
  s_mov_b32 s20, 0x1
  s_mov_b32 s21, 0x0
  s_mov_b32 s22, 0xffffff
  s_mov_b32 s23, 0x0
  s_mov_b32 s98, 0xf000f
  s_mov_b32 s99, 0xf000f
  s_mov_b64 exec, s[4:5]
  s_cmp_lt_u32 s2, 128
  s_cbranch_scc0 L_roleA
  s_load_dwordx2 s[32:33], s[0:1], 16
  s_mov_b32 s34, 5242880
  s_mov_b32 s35, 0x00020000
  s_load_dwordx2 s[36:37], s[0:1], 24
  s_mov_b32 s38, 4194304
  s_mov_b32 s39, 0x00020000
  s_load_dwordx2 s[40:41], s[0:1], 32
  s_mov_b32 s42, 4194304
  s_mov_b32 s43, 0x00020000
  s_load_dwordx2 s[44:45], s[0:1], 40
  s_mov_b32 s46, 5242880
  s_mov_b32 s47, 0x00020000
  s_load_dwordx2 s[52:53], s[0:1], 72
  s_mov_b32 s54, 2560
  s_mov_b32 s55, 0x00020000
  s_and_b32 s57, s2, 7
  s_lshr_b32 s63, s2, 5
  s_lshl_b32 s63, s63, 3
  s_or_b32 s57, s57, s63
  s_lshr_b32 s58, s2, 3
  s_and_b32 s58, s58, 3
  s_lshr_b32 s63, s56, 1
  s_and_b32 s63, s63, 1
  s_lshl_b32 s63, s63, 2
  v_or_b32 v14, s63, v3
  v_lshlrev_b32 v14, 1, v14
  v_xor_b32 v14, v14, v2
  v_lshlrev_b32 v14, 4, v14
  v_lshl_add_u32 v4, v3, 13, v14
  s_mul_i32 s63, s58, 1310720
  s_lshl_b32 s64, s57, 8
  s_add_u32 s63, s63, s64
  s_lshl_b32 s64, s56, 15
  s_add_u32 s63, s63, s64
  s_lshl_b32 s64, s56, 10
  s_waitcnt lgkmcnt(0)
  s_load_dword s60, s[48:49], 0
  s_cmp_lt_u32 s56, 2
  s_cbranch_scc0 L_nox_2
  s_mul_i32 s65, s56, 1280
  v_mul_u32_u24 v85, 20, v1
  v_add_u32 v85, s65, v85
  buffer_load_dwordx4 v[80:83], v85, s[28:31], 0 offen
  buffer_load_dword v84, v85, s[28:31], 0 offen offset:16
L_nox_2:
  s_mov_b32 m0, s64
  s_add_u32 s64, s64, 8192
  buffer_load_dwordx4 v4, s[32:35], s63 offen  lds
  s_add_u32 s63, s63, 262144
  s_mov_b32 m0, s64
  s_add_u32 s64, s64, 8192
  buffer_load_dwordx4 v4, s[32:35], s63 offen  lds
  s_add_u32 s63, s63, 262144
  s_mov_b32 m0, s64
  s_add_u32 s64, s64, 8192
  buffer_load_dwordx4 v4, s[32:35], s63 offen  lds
  s_add_u32 s63, s63, 262144
  s_mov_b32 m0, s64
  s_add_u32 s64, s64, 8192
  buffer_load_dwordx4 v4, s[32:35], s63 offen  lds
  s_add_u32 s63, s63, 262144
  s_mov_b32 m0, s64
  s_add_u32 s64, s64, 8192
  buffer_load_dwordx4 v4, s[32:35], s63 offen  lds
  s_barrier
  s_cmp_ge_u32 s56, 4
  s_cbranch_scc0 L_nouk_3
  s_lshl_b32 s63, s58, 7
  s_and_b32 s64, s56, 3
  s_lshl_b32 s64, s64, 5
  s_add_u32 s63, s63, s64
  s_lshl_b32 s63, s63, 13
  s_lshl_b32 s64, s57, 8
  s_add_u32 s63, s63, s64
  s_add_u32 s64, s63, 131072
  v_lshlrev_b32 v5, 13, v2
  v_lshl_add_u32 v5, v3, 4, v5
  buffer_load_dwordx4 v[16:19], v5, s[36:39], s63 offen offset:0
  buffer_load_dwordx4 v[20:23], v5, s[36:39], s63 offen offset:64
  buffer_load_dwordx4 v[24:27], v5, s[36:39], s63 offen offset:128
  buffer_load_dwordx4 v[28:31], v5, s[36:39], s63 offen offset:192
  buffer_load_dwordx4 v[32:35], v5, s[36:39], s64 offen offset:0
  buffer_load_dwordx4 v[36:39], v5, s[36:39], s64 offen offset:64
  buffer_load_dwordx4 v[40:43], v5, s[36:39], s64 offen offset:128
  buffer_load_dwordx4 v[44:47], v5, s[36:39], s64 offen offset:192
L_nouk_3:
  s_lshl_b32 s63, s57, 2
  s_add_u32 s63, s63, s56
  s_lshl_b32 s63, s63, 10
  v_lshlrev_b32 v9, 4, v1
  v_add_u32 v9, s63, v9
  s_lshl_b32 s65, s57, 2
  s_add_u32 s65, s65, s58
  s_lshl_b32 s78, s65, 14
  s_add_u32 s78, s78, 1310720
  s_lshl_b32 s65, s65, 10
  v_and_b32 v15, 1, v2
  v_lshlrev_b32 v15, 6, v15
  v_lshl_add_u32 v140, v3, 4, v15
  v_bfe_u32 v14, v2, 1, 1
  v_lshl_add_u32 v8, v14, 7, v140
  s_and_b32 s63, s56, 3
  s_lshl_b32 s63, s63, 8
  s_add_u32 s63, s63, s65
  v_add_u32 v8, s63, v8
  s_lshl_b32 s63, s57, 4
  s_lshl_b32 s64, s58, 2
  s_add_u32 s63, s63, s64
  s_and_b32 s64, s56, 3
  s_add_u32 s63, s63, s64
  s_lshl_b32 s63, s63, 7
  v_and_b32 v14, 1, v2
  v_lshlrev_b32 v168, 16, v14
  v_bfe_u32 v14, v2, 1, 1
  v_lshl_add_u32 v168, v14, 6, v168
  v_lshl_add_u32 v168, v3, 4, v168
  v_add_u32 v168, s63, v168
  s_lshl_b32 s27, s56, 1
  s_add_u32 s63, s56, 2
  s_cmp_lt_u32 s56, 4
  s_cselect_b32 s27, s27, s63
  v_lshrrev_b32 v14, 2, v2
  v_and_b32 v15, 1, v3
  v_lshl_or_b32 v15, v15, 2, v14
  v_lshlrev_b32 v15, 1, v15
  v_lshl_add_u32 v14, v3, 3, v14
  v_lshlrev_b32 v6, 8, v14
  v_bfe_u32 v14, v2, 1, 1
  s_and_b32 s63, s56, 3
  s_lshl_b32 s63, s63, 2
  v_or_b32 v14, s63, v14
  v_xor_b32 v14, v14, v15
  v_lshl_add_u32 v6, v14, 4, v6
  v_and_b32 v15, 1, v2
  v_lshl_add_u32 v6, v15, 3, v6
  v_xor_b32 v12, 32, v6
  s_mul_i32 s63, s58, 320
  s_add_u32 s63, s63, 40960
  v_mul_u32_u24 v7, 1280, v15
  v_lshl_add_u32 v7, v3, 4, v7
  v_add_u32 v7, s63, v7
  s_mul_i32 s63, s56, 576
  s_add_u32 s63, s63, 43520
  v_bfe_u32 v14, v1, 2, 1
  v_mul_u32_u24 v10, 288, v14
  v_lshrrev_b32 v14, 3, v1
  v_lshl_add_u32 v10, v14, 5, v10
  v_and_b32 v14, 3, v1
  v_lshl_add_u32 v10, v14, 3, v10
  v_add_u32 v10, s63, v10
  v_lshrrev_b32 v14, 2, v2
  v_lshlrev_b32 v14, 1, v14
  v_and_or_b32 v14, v2, 1, v14
  v_mul_u32_u24 v11, 288, v14
  v_lshl_add_u32 v11, v3, 4, v11
  v_add_u32 v11, 43520, v11
  s_waitcnt lgkmcnt(0)
  s_add_u32 s60, s60, 1
  s_and_b32 s61, s60, 0xff
  v_mov_b32 v13, s61
  s_mov_b32 s16, 0x07060302
  s_mov_b32 s8, 0x10001
  s_mov_b32 s9, 0xffff0000
  s_cmp_lt_u32 s56, 2
  s_cbranch_scc0 L_noln_10
  s_waitcnt vmcnt(5)
  v_lshlrev_b32 v96, 16, v80
  v_and_b32 v97, 0xffff0000, v80
  v_lshlrev_b32 v98, 16, v81
  v_and_b32 v99, 0xffff0000, v81
  v_lshlrev_b32 v100, 16, v82
  v_and_b32 v101, 0xffff0000, v82
  v_lshlrev_b32 v102, 16, v83
  v_and_b32 v103, 0xffff0000, v83
  v_lshlrev_b32 v104, 16, v84
  v_and_b32 v105, 0xffff0000, v84
  v_add_f32 v106, v96, v97
  v_add_f32 v107, v98, v99
  v_add_f32 v108, v100, v101
  v_add_f32 v109, v102, v103
  v_add_f32 v106, v106, v107
  v_add_f32 v108, v108, v109
  v_add_f32 v107, v104, v105
  v_add_f32 v106, v106, v108
  v_add_f32 v106, v106, v107
  s_nop 1
  v_add_f32_dpp v106, v106, v106 row_ror:1 row_mask:0xf bank_mask:0xf
  s_nop 1
  v_add_f32_dpp v106, v106, v106 row_ror:2 row_mask:0xf bank_mask:0xf
  s_nop 1
  v_add_f32_dpp v106, v106, v106 row_ror:4 row_mask:0xf bank_mask:0xf
  s_nop 1
  v_add_f32_dpp v106, v106, v106 row_ror:8 row_mask:0xf bank_mask:0xf
  v_mov_b32 v107, v106
  s_nop 1
  v_permlane16_swap_b32 v106, v107
  v_add_f32 v106, v106, v107
  v_mov_b32 v107, v106
  s_nop 1
  v_permlane32_swap_b32 v106, v107
  v_add_f32 v106, v106, v107
  v_mul_f32 v108, 0x3acccccd, v106
  v_sub_f32 v107, v96, v108
  v_mul_f32 v106, v107, v107
  v_sub_f32 v107, v97, v108
  v_fmac_f32 v106, v107, v107
  v_sub_f32 v107, v98, v108
  v_fmac_f32 v106, v107, v107
  v_sub_f32 v107, v99, v108
  v_fmac_f32 v106, v107, v107
  v_sub_f32 v107, v100, v108
  v_fmac_f32 v106, v107, v107
  v_sub_f32 v107, v101, v108
  v_fmac_f32 v106, v107, v107
  v_sub_f32 v107, v102, v108
  v_fmac_f32 v106, v107, v107
  v_sub_f32 v107, v103, v108
  v_fmac_f32 v106, v107, v107
  v_sub_f32 v107, v104, v108
  v_fmac_f32 v106, v107, v107
  v_sub_f32 v107, v105, v108
  v_fmac_f32 v106, v107, v107
  s_nop 1
  v_add_f32_dpp v106, v106, v106 row_ror:1 row_mask:0xf bank_mask:0xf
  s_nop 1
  v_add_f32_dpp v106, v106, v106 row_ror:2 row_mask:0xf bank_mask:0xf
  s_nop 1
  v_add_f32_dpp v106, v106, v106 row_ror:4 row_mask:0xf bank_mask:0xf
  s_nop 1
  v_add_f32_dpp v106, v106, v106 row_ror:8 row_mask:0xf bank_mask:0xf
  v_mov_b32 v107, v106
  s_nop 1
  v_permlane16_swap_b32 v106, v107
  v_add_f32 v106, v106, v107
  v_mov_b32 v107, v106
  s_nop 1
  v_permlane32_swap_b32 v106, v107
  v_add_f32 v106, v106, v107
  v_cvt_pk_bf16_f32 v109, v108, v108
  v_and_b32 v109, 0xffff0000, v109
  v_mul_f32 v106, 0x3acccccd, v106
  v_cvt_pk_bf16_f32 v106, v106, v106
  v_and_b32 v106, 0xffff0000, v106
  v_add_f32 v106, 0x3727c5ac, v106
  v_cvt_pk_bf16_f32 v106, v106, v106
  v_and_b32 v106, 0xffff0000, v106
  v_sqrt_f32 v106, v106
  v_sub_f32 v96, v96, v109
  v_sub_f32 v97, v97, v109
  v_sub_f32 v98, v98, v109
  v_sub_f32 v99, v99, v109
  v_sub_f32 v100, v100, v109
  v_sub_f32 v101, v101, v109
  v_sub_f32 v102, v102, v109
  v_sub_f32 v103, v103, v109
  v_sub_f32 v104, v104, v109
  v_sub_f32 v105, v105, v109
  v_cvt_pk_bf16_f32 v106, v106, v106
  v_and_b32 v106, 0xffff0000, v106
  v_rcp_f32 v106, v106
  v_cvt_pk_bf16_f32 v80, v96, v97
  v_cvt_pk_bf16_f32 v81, v98, v99
  v_cvt_pk_bf16_f32 v82, v100, v101
  v_cvt_pk_bf16_f32 v83, v102, v103
  v_cvt_pk_bf16_f32 v84, v104, v105
  v_lshlrev_b32 v96, 16, v80
  v_and_b32 v97, 0xffff0000, v80
  v_lshlrev_b32 v98, 16, v81
  v_and_b32 v99, 0xffff0000, v81
  v_lshlrev_b32 v100, 16, v82
  v_and_b32 v101, 0xffff0000, v82
  v_lshlrev_b32 v102, 16, v83
  v_and_b32 v103, 0xffff0000, v83
  v_lshlrev_b32 v104, 16, v84
  v_and_b32 v105, 0xffff0000, v84
  v_mul_f32 v96, v96, v106
  v_mul_f32 v97, v97, v106
  v_mul_f32 v98, v98, v106
  v_mul_f32 v99, v99, v106
  v_mul_f32 v100, v100, v106
  v_mul_f32 v101, v101, v106
  v_mul_f32 v102, v102, v106
  v_mul_f32 v103, v103, v106
  v_mul_f32 v104, v104, v106
  v_mul_f32 v105, v105, v106
  v_add_u32 v107, 40960, v85
  v_cvt_pk_bf16_f32 v80, v96, v97
  ds_write_b32 v107, v80 offset:0
  v_cvt_pk_bf16_f32 v81, v98, v99
  ds_write_b32 v107, v81 offset:4
  v_cvt_pk_bf16_f32 v82, v100, v101
  ds_write_b32 v107, v82 offset:8
  v_cvt_pk_bf16_f32 v83, v102, v103
  ds_write_b32 v107, v83 offset:12
  v_cvt_pk_bf16_f32 v84, v104, v105
  ds_write_b32 v107, v84 offset:16
L_noln_10:
  s_cmp_lt_u32 s56, 4
  s_cbranch_scc0 L_pub1_11
  s_waitcnt vmcnt(0)
  s_branch L_b1_12
L_pub1_11:
  s_waitcnt vmcnt(8)
L_b1_12:
  s_waitcnt lgkmcnt(0)
  s_barrier
  s_mov_b32 s65, 65536
  s_mov_b32 s66, 196608
  s_cmp_lt_u32 s56, 4
  s_cbranch_scc1 L_gatherq_13
  ds_read_b128 v[80:83], v7 offset:0
  ds_read_b64_tr_b16 v[148:149], v6 offset:0
  ds_read_b64_tr_b16 v[150:151], v6 offset:1024
  ds_read_b64_tr_b16 v[100:101], v12 offset:0
  ds_read_b64_tr_b16 v[102:103], v12 offset:1024
  ds_read_b128 v[84:87], v7 offset:64
  ds_read_b64_tr_b16 v[152:153], v6 offset:8192
  ds_read_b64_tr_b16 v[154:155], v6 offset:9216
  ds_read_b64_tr_b16 v[104:105], v12 offset:8192
  ds_read_b64_tr_b16 v[106:107], v12 offset:9216
  ds_read_b128 v[88:91], v7 offset:128
  ds_read_b64_tr_b16 v[156:157], v6 offset:16384
  ds_read_b64_tr_b16 v[158:159], v6 offset:17408
  ds_read_b64_tr_b16 v[108:109], v12 offset:16384
  ds_read_b64_tr_b16 v[110:111], v12 offset:17408
  s_waitcnt lgkmcnt(10)
  v_mfma_f32_16x16x32_bf16 v[132:135], v[148:151], v[80:83], 0
  v_mfma_f32_16x16x32_bf16 v[136:139], v[100:103], v[80:83], 0
  ds_read_b128 v[92:95], v7 offset:192
  ds_read_b64_tr_b16 v[160:161], v6 offset:24576
  ds_read_b64_tr_b16 v[162:163], v6 offset:25600
  ds_read_b64_tr_b16 v[112:113], v12 offset:24576
  ds_read_b64_tr_b16 v[114:115], v12 offset:25600
  s_waitcnt lgkmcnt(10)
  v_mfma_f32_16x16x32_bf16 v[132:135], v[152:155], v[84:87], v[132:135]
  v_mfma_f32_16x16x32_bf16 v[136:139], v[104:107], v[84:87], v[136:139]
  ds_read_b128 v[96:99], v7 offset:256
  ds_read_b64_tr_b16 v[164:165], v6 offset:32768
  ds_read_b64_tr_b16 v[166:167], v6 offset:33792
  ds_read_b64_tr_b16 v[116:117], v12 offset:32768
  ds_read_b64_tr_b16 v[118:119], v12 offset:33792
  s_waitcnt lgkmcnt(10)
  v_mfma_f32_16x16x32_bf16 v[132:135], v[156:159], v[88:91], v[132:135]
  v_mfma_f32_16x16x32_bf16 v[136:139], v[108:111], v[88:91], v[136:139]
  s_waitcnt lgkmcnt(5)
  v_mfma_f32_16x16x32_bf16 v[132:135], v[160:163], v[92:95], v[132:135]
  v_mfma_f32_16x16x32_bf16 v[136:139], v[112:115], v[92:95], v[136:139]
  s_waitcnt lgkmcnt(0)
  v_mfma_f32_16x16x32_bf16 v[132:135], v[164:167], v[96:99], v[132:135]
  v_mfma_f32_16x16x32_bf16 v[136:139], v[116:119], v[96:99], v[136:139]
  s_nop 7
  v_cndmask_b32 v132, v132, v136, s[100:101]
  v_cndmask_b32 v133, v133, v137, s[100:101]
  v_cndmask_b32 v134, v134, v138, s[100:101]
  v_cndmask_b32 v135, v135, v139, s[100:101]
  v_cvt_pk_bf16_f32 v136, v132, v133
  v_cvt_pk_bf16_f32 v137, v134, v135
  v_lshl_or_b32 v132, v136, 16, v13
  v_and_or_b32 v133, v136, s9, v13
  v_lshl_or_b32 v134, v137, 16, v13
  v_and_or_b32 v135, v137, s9, v13
  s_mov_b64 exec, s[98:99]
  buffer_store_dwordx4 v[132:135], v8, s[48:51], s65 offen
  buffer_store_dwordx4 v[132:135], v8, s[48:51], s66 offen sc1
  s_mov_b64 exec, s[4:5]
  v_mov_b32 v88, 0
  v_mov_b32 v89, 1
  v_mov_b32 v90, 0
  v_mov_b32 v91, 1
  s_mov_b32 s67, 589824
  s_and_b32 s63, s56, 3
  s_lshl_b32 s63, s63, 1
  s_mul_i32 s64, s58, 10
  s_add_u32 s63, s63, s64
  s_lshl_b32 s63, s63, 6
  s_add_u32 s63, s63, s57
  s_lshl_b32 s63, s63, 7
  s_add_u32 s63, s63, 917504
  v_bfe_u32 v14, v2, 1, 1
  v_lshl_add_u32 v14, v14, 13, v140
  s_mov_b64 exec, s[98:99]
  buffer_store_dwordx4 v[88:91], v168, s[48:51], s67 offen sc1
  buffer_store_dwordx4 v[88:91], v14, s[48:51], s63 offen sc1
  s_cmp_eq_u32 s56, 4
  s_cbranch_scc0 L_pw47_15
  s_add_u32 s63, s63, 65536
  buffer_store_dwordx4 v[88:91], v14, s[48:51], s63 offen sc1
L_pw47_15:
  s_mov_b64 exec, s[4:5]
  s_branch L_barq_14
L_gatherq_13:
  s_mov_b32 s79, 4
L_fast_18:
  buffer_load_dwordx4 v[80:83], v9, s[48:51], s65 offen sc1
  s_waitcnt vmcnt(0)
  v_bitop3_b32 v88, v80, v81, v13 bitop3:0x7e
  v_bitop3_b32 v88, v88, v82, v13 bitop3:0xf6
  v_bitop3_b32 v88, v88, v83, v13 bitop3:0xf6
  v_and_b32 v88, 0xff, v88
  v_cmp_ne_u32 vcc, 0, v88
  s_cbranch_vccz L_gok_17
  s_sub_u32 s79, s79, 1
  s_cmp_lg_u32 s79, 0
  s_cbranch_scc1 L_fast_18
L_look_16:
  buffer_load_dwordx4 v[80:83], v9, s[48:51], s65 offen sc1
  buffer_load_dwordx4 v[84:87], v9, s[48:51], s66 offen sc1
  s_waitcnt vmcnt(1)
  v_bitop3_b32 v88, v80, v81, v13 bitop3:0x7e
  v_bitop3_b32 v88, v88, v82, v13 bitop3:0xf6
  v_bitop3_b32 v88, v88, v83, v13 bitop3:0xf6
  v_and_b32 v88, 0xff, v88
  v_cmp_ne_u32 vcc, 0, v88
  s_cbranch_vccz L_gok_17
  s_waitcnt vmcnt(0)
  v_bitop3_b32 v88, v84, v85, v13 bitop3:0x7e
  v_bitop3_b32 v88, v88, v86, v13 bitop3:0xf6
  v_bitop3_b32 v88, v88, v87, v13 bitop3:0xf6
  v_and_b32 v88, 0xff, v88
  v_cmp_ne_u32 vcc, 0, v88
  s_add_u32 s62, s62, 1
  s_cbranch_vccz L_pd_19
  s_cmp_lt_u32 s62, 400000
  s_cbranch_scc1 L_look_16
L_pd_19:
  v_mov_b32 v80, v84
  v_mov_b32 v81, v85
  v_mov_b32 v82, v86
  v_mov_b32 v83, v87
L_gok_17:
  v_perm_b32 v88, v81, v80, s16
  v_perm_b32 v89, v83, v82, s16
  ds_write_b64 v10, v[88:89]
L_barq_14:
  s_waitcnt lgkmcnt(0)
  s_barrier
  s_cmp_ge_u32 s56, 4
  s_cbranch_scc0 L_nop1_20
  ds_read_b128 v[92:95], v11 offset:0
  ds_read_b128 v[96:99], v11 offset:64
  ds_read_b128 v[100:103], v11 offset:128
  ds_read_b128 v[104:107], v11 offset:192
  s_mov_b32 s63, 0x3e0293ee
  s_mov_b32 s64, 589824
  s_waitcnt vmcnt(4)
  s_waitcnt lgkmcnt(3)
  v_mfma_f32_16x16x32_bf16 v[132:135], v[16:19], v[92:95], 0
  v_mfma_f32_16x16x32_bf16 v[136:139], v[32:35], v[92:95], 0
  s_waitcnt lgkmcnt(2)
  v_mfma_f32_16x16x32_bf16 v[132:135], v[20:23], v[96:99], v[132:135]
  v_mfma_f32_16x16x32_bf16 v[136:139], v[36:39], v[96:99], v[136:139]
  s_waitcnt lgkmcnt(1)
  v_mfma_f32_16x16x32_bf16 v[132:135], v[24:27], v[100:103], v[132:135]
  v_mfma_f32_16x16x32_bf16 v[136:139], v[40:43], v[100:103], v[136:139]
  s_waitcnt lgkmcnt(0)
  v_mfma_f32_16x16x32_bf16 v[132:135], v[28:31], v[104:107], v[132:135]
  v_mfma_f32_16x16x32_bf16 v[136:139], v[44:47], v[104:107], v[136:139]
  s_nop 7
  v_cndmask_b32 v132, v132, v136, s[100:101]
  v_cndmask_b32 v133, v133, v137, s[100:101]
  v_cndmask_b32 v134, v134, v138, s[100:101]
  v_cndmask_b32 v135, v135, v139, s[100:101]
  v_add_f32_dpp v132, v132, v132 row_ror:4 row_mask:0xf bank_mask:0xf
  v_add_f32_dpp v133, v133, v133 row_ror:4 row_mask:0xf bank_mask:0xf
  v_add_f32_dpp v134, v134, v134 row_ror:4 row_mask:0xf bank_mask:0xf
  v_add_f32_dpp v135, v135, v135 row_ror:4 row_mask:0xf bank_mask:0xf
  v_add_f32_dpp v132, v132, v132 row_ror:8 row_mask:0xf bank_mask:0xf
  v_add_f32_dpp v133, v133, v133 row_ror:8 row_mask:0xf bank_mask:0xf
  v_add_f32_dpp v134, v134, v134 row_ror:8 row_mask:0xf bank_mask:0xf
  v_add_f32_dpp v135, v135, v135 row_ror:8 row_mask:0xf bank_mask:0xf
  v_mul_f32 v132, s63, v132
  v_mul_f32 v133, s63, v133
  v_mul_f32 v134, s63, v134
  v_mul_f32 v135, s63, v135
  v_cvt_pk_bf16_f32 v136, v132, v133
  v_cvt_pk_bf16_f32 v137, v134, v135
  v_lshl_or_b32 v132, v136, 16, v13
  v_and_or_b32 v133, v136, s9, v13
  v_lshl_or_b32 v134, v137, 16, v13
  v_and_or_b32 v135, v137, s9, v13
  s_mov_b64 exec, s[98:99]
  buffer_store_dwordx4 v[132:135], v168, s[48:51], s64 offen sc1
  s_mov_b64 exec, s[4:5]
L_nop1_20:
  v_add_u32 v80, 0, v1
  v_mul_u32_u24 v81, 3277, v80
  v_lshrrev_b32 v81, 16, v81
  v_mul_u32_u24 v88, 20, v81
  v_sub_u32 v80, v80, v88
  v_mul_u32_u24 v88, 1280, v81
  v_lshl_add_u32 v88, v80, 4, v88
  v_add_u32 v80, 64, v1
  v_mul_u32_u24 v81, 3277, v80
  v_lshrrev_b32 v81, 16, v81
  v_mul_u32_u24 v89, 20, v81
  v_sub_u32 v80, v80, v89
  v_mul_u32_u24 v89, 1280, v81
  v_lshl_add_u32 v89, v80, 4, v89
  v_add_u32 v80, 128, v1
  v_mul_u32_u24 v81, 3277, v80
  v_lshrrev_b32 v81, 16, v81
  v_mul_u32_u24 v90, 20, v81
  v_sub_u32 v80, v80, v90
  v_mul_u32_u24 v90, 1280, v81
  v_lshl_add_u32 v90, v80, 4, v90
  v_add_u32 v80, 192, v1
  v_mul_u32_u24 v81, 3277, v80
  v_lshrrev_b32 v81, 16, v81
  v_mul_u32_u24 v91, 20, v81
  v_sub_u32 v80, v80, v91
  v_mul_u32_u24 v91, 1280, v81
  v_lshl_add_u32 v91, v80, 4, v91
  v_add_u32 v80, 256, v1
  v_mul_u32_u24 v81, 3277, v80
  v_lshrrev_b32 v81, 16, v81
  v_mul_u32_u24 v92, 20, v81
  v_sub_u32 v80, v80, v92
  v_mul_u32_u24 v92, 1280, v81
  v_lshl_add_u32 v92, v80, 4, v92
  v_add_u32 v120, 49152, v6
  v_add_u32 v141, 49152, v12
  v_lshrrev_b32 v14, 2, v2
  v_lshl_add_u32 v15, v3, 3, v14
  v_mul_u32_u24 v121, 320, v15
  v_lshl_add_u32 v15, v3, 2, v14
  v_mul_u32_u24 v125, 288, v15
  v_and_b32 v14, 3, v2
  v_lshl_add_u32 v121, v14, 3, v121
  v_lshl_add_u32 v125, v14, 3, v125
  s_lshl_b32 s63, s27, 5
  s_add_u32 s64, s63, 81920
  v_add_u32 v121, s64, v121
  s_lshl_b32 s63, s56, 5
  s_add_u32 s64, s63, 122880
  v_add_u32 v125, s64, v125
  s_lshl_b32 s63, s56, 3
  v_add_u32 v14, s63, v3
  v_lshlrev_b32 v122, 8, v14
  v_lshl_add_u32 v122, v2, 4, v122
  v_mul_u32_u24 v123, 288, v14
  v_lshl_add_u32 v123, v2, 4, v123
  v_add_u32 v123, 122880, v123
  s_lshr_b32 s63, s57, 4
  s_lshl_b32 s63, s63, 13
  s_and_b32 s64, s57, 15
  s_lshl_b32 s64, s64, 3
  s_add_u32 s63, s63, s64
  s_add_u32 s63, s63, 851968
  v_lshlrev_b32 v124, 7, v1
  v_add_u32 v124, s63, v124
  v_lshrrev_b32 v14, 5, v1
  v_mul_u32_u24 v126, 192, v14
  v_lshlrev_b32 v131, 2, v14
  v_add_u32 v131, 46656, v131
  v_bfe_u32 v14, v1, 2, 2
  v_lshl_add_u32 v126, v14, 4, v126
  v_bfe_u32 v14, v1, 4, 1
  v_lshl_add_u32 v126, v14, 3, v126
  v_and_b32 v14, 3, v1
  v_lshl_add_u32 v126, v14, 1, v126
  v_add_u32 v126, 46400, v126
  v_and_b32 v14, 1, v2
  v_lshlrev_b32 v127, 7, v14
  v_lshl_add_u32 v127, v3, 4, v127
  v_add_u32 v127, 46400, v127
  v_mul_u32_u24 v129, 288, v14
  v_add_u32 v129, 45824, v129
  s_lshl_b32 s63, s56, 5
  v_lshl_add_u32 v128, v3, 3, v129
  v_add_u32 v128, s63, v128
  v_lshl_add_u32 v129, v3, 4, v129
  s_mul_i32 s63, s58, 10
  s_add_u32 s63, s63, s27
  s_lshl_b32 s63, s63, 6
  s_add_u32 s63, s63, s57
  s_lshl_b32 s63, s63, 7
  s_add_u32 s63, s63, 917504
  v_lshlrev_b32 v130, 6, v14
  v_lshl_add_u32 v130, v3, 4, v130
  v_bfe_u32 v14, v2, 1, 1
  v_lshl_add_u32 v130, v14, 13, v130
  v_add_u32 v130, s63, v130
  v_lshlrev_b32 v142, 4, v1
  v_mov_b32 v147, 0
  s_mul_i32 s63, s58, 320
  s_lshl_b32 s64, s57, 5
  s_add_u32 s63, s63, s64
  v_bfe_u32 v146, v1, 2, 1
  v_mul_u32_u24 v146, 1280, v146
  v_and_b32 v14, 3, v1
  v_lshl_add_u32 v146, v14, 3, v146
  v_lshl_add_u32 v146, v3, 1, v146
  v_add_u32 v146, s63, v146
  v_mul_u32_u24 v80, 0x9d, v2
  v_add_u32 v80, 0x35, v80
  v_xor_b32 v80, s61, v80
  v_bfe_u32 v81, v80, 1, 1
  v_bfe_u32 v170, v80, 0, 1
  v_lshl_or_b32 v170, v81, 16, v170
  v_bfe_u32 v81, v80, 3, 1
  v_bfe_u32 v171, v80, 2, 1
  v_lshl_or_b32 v171, v81, 16, v171
  v_bfe_u32 v81, v80, 5, 1
  v_bfe_u32 v172, v80, 4, 1
  v_lshl_or_b32 v172, v81, 16, v172
  v_bfe_u32 v81, v80, 7, 1
  v_bfe_u32 v173, v80, 6, 1
  v_lshl_or_b32 v173, v81, 16, v173
  s_mov_b64 s[4:5], 0
  s_mov_b64 s[70:71], 0
  s_mov_b64 s[72:73], 0
  s_mov_b64 s[6:7], 0
  s_mov_b64 s[18:19], 0
  s_mov_b64 s[20:21], 0
  s_mov_b64 s[22:23], 0
  s_mov_b64 s[98:99], 0
  s_mov_b64 exec, s[4:5]
  s_mov_b32 s26, s56
  s_cmp_eq_u32 s26, 0
  s_cbranch_scc0 L_dj_30
  s_mov_b32 s56, 0
  s_branch L_pW0_21
L_dj_30:
  s_cmp_eq_u32 s26, 1
  s_cbranch_scc0 L_dj_31
  s_mov_b32 s56, 0
  s_branch L_pW1_22
L_dj_31:
  s_cmp_eq_u32 s26, 2
  s_cbranch_scc0 L_dj_32
  s_mov_b32 s56, 0
  s_branch L_pW2_23
L_dj_32:
  s_cmp_eq_u32 s26, 3
  s_cbranch_scc0 L_dj_33
  s_mov_b32 s56, 4
  s_branch L_pW3_24
L_dj_33:
  s_cmp_eq_u32 s26, 4
  s_cbranch_scc0 L_dj_34
  s_mov_b32 s56, 0
  s_branch L_pW4_25
L_dj_34:
  s_cmp_eq_u32 s26, 5
  s_cbranch_scc0 L_dj_35
  s_mov_b32 s56, 0
  s_branch L_pW5_26
L_dj_35:
  s_cmp_eq_u32 s26, 6
  s_cbranch_scc0 L_dj_36
  s_mov_b32 s56, 3
  s_branch L_pW6_27
L_dj_36:
  s_cmp_eq_u32 s26, 7
  s_cbranch_scc0 L_dj_37
  s_mov_b32 s56, 3
  s_branch L_pW7_28
L_dj_37:
  s_branch L_dryWx_29
L_dryWx_29:
  s_mov_b32 s56, s26
  s_mov_b32 s4, 0xffffffff
  s_mov_b32 s5, 0xffffffff
  s_mov_b32 s70, 0x30003
  s_mov_b32 s71, 0x30003
  s_mov_b32 s72, 0xffffffff
  s_mov_b32 s73, 0x0
  s_mov_b32 s6, 0xffff
  s_mov_b32 s7, 0x0
  s_mov_b32 s18, 0xff00ff
  s_mov_b32 s19, 0xff00ff
  s_mov_b32 s20, 0x1
  s_mov_b32 s21, 0x0
  s_mov_b32 s22, 0xffffff
  s_mov_b32 s23, 0x0
  s_mov_b32 s98, 0xf000f
  s_mov_b32 s99, 0xf000f
  s_mov_b64 exec, s[4:5]
  buffer_load_ushort v144, v146, s[28:31], 0 offen
  s_lshl_b32 s63, s58, 20
  s_lshl_b32 s64, s57, 8
  s_add_u32 s63, s63, s64
  s_lshl_b32 s64, s56, 15
  s_add_u32 s63, s63, s64
  s_lshl_b32 s64, s56, 10
  s_add_u32 s64, s64, 49152
  s_mov_b32 m0, s64
  s_add_u32 s64, s64, 8192
  buffer_load_dwordx4 v4, s[40:43], s63 offen  lds
  s_add_u32 s63, s63, 262144
  s_mov_b32 m0, s64
  s_add_u32 s64, s64, 8192
  buffer_load_dwordx4 v4, s[40:43], s63 offen  lds
  s_add_u32 s63, s63, 262144
  s_mov_b32 m0, s64
  s_add_u32 s64, s64, 8192
  buffer_load_dwordx4 v4, s[40:43], s63 offen  lds
  s_add_u32 s63, s63, 262144
  s_mov_b32 m0, s64
  s_add_u32 s64, s64, 8192
  buffer_load_dwordx4 v4, s[40:43], s63 offen  lds
  s_mul_i32 s63, s57, 163840
  s_mul_i32 s64, s56, 20480
  s_add_u32 s63, s63, s64
  s_mul_i32 s64, s58, 320
  s_add_u32 s63, s63, s64
  s_mul_i32 s64, s56, 5120
  s_add_u32 s64, s64, 81920
  s_mov_b32 m0, s64
  s_add_u32 s64, s64, 1024
  buffer_load_dwordx4 v88, s[44:47], s63 offen  lds
  s_mov_b32 m0, s64
  s_add_u32 s64, s64, 1024
  buffer_load_dwordx4 v89, s[44:47], s63 offen  lds
  s_mov_b32 m0, s64
  s_add_u32 s64, s64, 1024
  buffer_load_dwordx4 v90, s[44:47], s63 offen  lds
  s_mov_b32 m0, s64
  s_add_u32 s64, s64, 1024
  buffer_load_dwordx4 v91, s[44:47], s63 offen  lds
  s_mov_b32 m0, s64
  s_add_u32 s64, s64, 1024
  buffer_load_dwordx4 v92, s[44:47], s63 offen  lds
  s_cmp_lt_u32 s56, 4
  s_cbranch_scc0 L_vt3_38
  s_mov_b32 s64, 327680
  buffer_load_dword v143, v9, s[48:51], s64 offen sc1
L_vt3_38:
  s_waitcnt vmcnt(0)
  s_barrier
  s_cmp_lt_u32 s56, 4
  s_cbranch_scc0 L_fr47_39
  ds_read_b64_tr_b16 v[48:49], v121 offset:0
  ds_read_b64_tr_b16 v[50:51], v121 offset:1280
  ds_read_b64_tr_b16 v[52:53], v121 offset:10240
  ds_read_b64_tr_b16 v[54:55], v121 offset:11520
  ds_read_b64_tr_b16 v[56:57], v121 offset:20480
  ds_read_b64_tr_b16 v[58:59], v121 offset:21760
  ds_read_b64_tr_b16 v[60:61], v121 offset:30720
  ds_read_b64_tr_b16 v[62:63], v121 offset:32000
  ds_read_b64_tr_b16 v[64:65], v121 offset:32
  ds_read_b64_tr_b16 v[66:67], v121 offset:1312
  ds_read_b64_tr_b16 v[68:69], v121 offset:10272
  ds_read_b64_tr_b16 v[70:71], v121 offset:11552
  ds_read_b64_tr_b16 v[72:73], v121 offset:20512
  ds_read_b64_tr_b16 v[74:75], v121 offset:21792
  ds_read_b64_tr_b16 v[76:77], v121 offset:30752
  ds_read_b64_tr_b16 v[78:79], v121 offset:32032
  s_branch L_frdone_40
L_fr47_39:
  ds_read_b64_tr_b16 v[32:33], v120 offset:0
  ds_read_b64_tr_b16 v[34:35], v120 offset:1024
  ds_read_b64_tr_b16 v[36:37], v120 offset:8192
  ds_read_b64_tr_b16 v[38:39], v120 offset:9216
  ds_read_b64_tr_b16 v[40:41], v120 offset:16384
  ds_read_b64_tr_b16 v[42:43], v120 offset:17408
  ds_read_b64_tr_b16 v[44:45], v120 offset:24576
  ds_read_b64_tr_b16 v[46:47], v120 offset:25600
  ds_read_b64_tr_b16 v[148:149], v141 offset:0
  ds_read_b64_tr_b16 v[150:151], v141 offset:1024
  ds_read_b64_tr_b16 v[152:153], v141 offset:8192
  ds_read_b64_tr_b16 v[154:155], v141 offset:9216
  ds_read_b64_tr_b16 v[156:157], v141 offset:16384
  ds_read_b64_tr_b16 v[158:159], v141 offset:17408
  ds_read_b64_tr_b16 v[160:161], v141 offset:24576
  ds_read_b64_tr_b16 v[162:163], v141 offset:25600
  ds_read_b64_tr_b16 v[48:49], v121 offset:0
  ds_read_b64_tr_b16 v[50:51], v121 offset:1280
  ds_read_b64_tr_b16 v[52:53], v121 offset:10240
  ds_read_b64_tr_b16 v[54:55], v121 offset:11520
  ds_read_b64_tr_b16 v[56:57], v121 offset:20480
  ds_read_b64_tr_b16 v[58:59], v121 offset:21760
  ds_read_b64_tr_b16 v[60:61], v121 offset:30720
  ds_read_b64_tr_b16 v[62:63], v121 offset:32000
L_frdone_40:
  s_cmp_eq_u32 s56, 0
  s_cbranch_scc0 L_nostat_41
  s_mov_b32 s64, 16384
L_pollS_42:
  buffer_load_dwordx2 v[96:97], v124, s[48:51], 0 offen sc1
  buffer_load_dwordx2 v[94:95], v124, s[48:51], s64 offen sc1
  s_waitcnt vmcnt(0)
  v_cmp_ne_u32 vcc, s60, v97
  v_cmp_ne_u32 s[74:75], s60, v95
  s_nop 0
  s_or_b64 vcc, vcc, s[74:75]
  s_add_u32 s62, s62, 1
  s_cbranch_vccz L_pd_43
  s_cmp_lt_u32 s62, 400000
  s_cbranch_scc1 L_pollS_42
L_pd_43:
L_nostat_41:
  s_cbranch_execz L_dryWx_29
  s_barrier
L_pW0_21:
  s_cbranch_execz L_skipmem_1
  buffer_load_dwordx4 v[80:83], v122, s[48:51], s78 offen sc1
  buffer_load_dwordx4 v[84:87], v122, s[48:51], s78 offen offset:1024 sc1
L_skipmem_1:
  s_cmp_eq_u32 s56, 0
  s_cbranch_scc0 L_nowgt_44
  v_mov_b32 v98, v96
  s_nop 1
  v_max_f32_dpp v98, v98, v98 row_ror:1 row_mask:0xf bank_mask:0xf
  s_nop 1
  v_max_f32_dpp v98, v98, v98 row_ror:2 row_mask:0xf bank_mask:0xf
  s_nop 1
  v_max_f32_dpp v98, v98, v98 row_ror:4 row_mask:0xf bank_mask:0xf
  s_nop 1
  v_max_f32_dpp v98, v98, v98 row_ror:8 row_mask:0xf bank_mask:0xf
  v_mov_b32 v100, v98
  s_nop 1
  v_permlane16_swap_b32 v98, v100
  v_max_f32 v98, v98, v100
  v_sub_f32 v99, v96, v98
  v_exp_f32 v99, v99
  v_lshrrev_b32 v102, 5, v1
  v_lshlrev_b32 v102, 8, v102
  v_sub_u32 v102, 128, v102
  v_add_u32 v102, v126, v102
  v_mov_b32 v101, 0
  v_cvt_pk_bf16_f32 v100, v99, v99
  ds_write_b16 v126, v100
  ds_write_b16 v102, v101
  v_and_b32 v99, 0xffff0000, v100
  v_mul_f32 v99, v99, v94
  s_nop 1
  v_add_f32_dpp v99, v99, v99 row_ror:1 row_mask:0xf bank_mask:0xf
  s_nop 1
  v_add_f32_dpp v99, v99, v99 row_ror:2 row_mask:0xf bank_mask:0xf
  s_nop 1
  v_add_f32_dpp v99, v99, v99 row_ror:4 row_mask:0xf bank_mask:0xf
  s_nop 1
  v_add_f32_dpp v99, v99, v99 row_ror:8 row_mask:0xf bank_mask:0xf
  v_mov_b32 v100, v99
  s_nop 1
  v_permlane16_swap_b32 v99, v100
  v_add_f32 v99, v99, v100
  v_rcp_f32 v99, v99
  ds_write_b32 v131, v99
L_nowgt_44:
  s_cbranch_execz L_dryWx_29
L_pW1_22:
  v_and_b32 v93, 1, v2
  v_lshlrev_b32 v93, 2, v93
  s_waitcnt vmcnt(0)
  v_xor_b32 v80, v80, v170
  v_xor_b32 v81, v81, v171
  v_xor_b32 v82, v82, v172
  v_xor_b32 v83, v83, v173
  v_xor_b32 v84, v84, v170
  v_xor_b32 v85, v85, v171
  v_xor_b32 v86, v86, v172
  v_xor_b32 v87, v87, v173
  v_or3_b32 v90, v80, v81, v82
  v_or3_b32 v90, v90, v83, v84
  v_or3_b32 v90, v90, v85, v86
  v_or_b32 v90, v90, v87
  v_and_b32 v90, 0x10001, v90
  v_cmp_ne_u32 vcc, 0, v90
  s_cbranch_vccz L_Ook_46
L_pollO_45:
  s_cbranch_execz L_skipmem_2
  buffer_load_dwordx4 v[80:83], v122, s[48:51], s78 offen sc1
  buffer_load_dwordx4 v[84:87], v122, s[48:51], s78 offen offset:1024 sc1
L_skipmem_2:
  s_waitcnt vmcnt(0)
  v_xor_b32 v80, v80, v170
  v_xor_b32 v81, v81, v171
  v_xor_b32 v82, v82, v172
  v_xor_b32 v83, v83, v173
  v_xor_b32 v84, v84, v170
  v_xor_b32 v85, v85, v171
  v_xor_b32 v86, v86, v172
  v_xor_b32 v87, v87, v173
  v_or3_b32 v90, v80, v81, v82
  v_or3_b32 v90, v90, v83, v84
  v_or3_b32 v90, v90, v85, v86
  v_or_b32 v90, v90, v87
  v_and_b32 v90, 0x10001, v90
  v_cmp_ne_u32 vcc, 0, v90
  s_add_u32 s62, s62, 1
  s_cbranch_vccz L_pd_47
  s_cmp_lt_u32 s62, 400000
  s_cbranch_scc1 L_pollO_45
L_pd_47:
L_Ook_46:
  ds_write_b128 v123, v[80:83]
  ds_write_b128 v123, v[84:87] offset:1152
  s_waitcnt lgkmcnt(0)
  s_cbranch_execz L_dryWx_29
  s_barrier
L_pW2_23:
  ds_read_b64_tr_b16 v[96:97], v125 offset:0
  ds_read_b64_tr_b16 v[98:99], v125 offset:4608
  ds_read_b128 v[104:107], v127 offset:0
  ds_read_b64_tr_b16 v[100:101], v125 offset:9216
  ds_read_b64_tr_b16 v[102:103], v125 offset:13824
  ds_read_b128 v[108:111], v127 offset:64
  ds_read_b32 v92, v93 offset:46656
  s_waitcnt lgkmcnt(4)
  v_mfma_f32_16x16x32_bf16 v[132:135], v[96:99], v[104:107], 0
  s_waitcnt lgkmcnt(1)
  v_mfma_f32_16x16x32_bf16 v[132:135], v[100:103], v[108:111], v[132:135]
  s_waitcnt lgkmcnt(0)
  s_nop 6
  v_mul_f32 v132, v132, v92
  v_mul_f32 v133, v133, v92
  v_mul_f32 v134, v134, v92
  v_mul_f32 v135, v135, v92
  v_cvt_pk_bf16_f32 v132, v132, v133
  v_cvt_pk_bf16_f32 v133, v134, v135
  ds_write_b64 v128, v[132:133]
  s_mov_b32 s65, 327680
  s_mov_b32 s66, 458752
  s_waitcnt lgkmcnt(0)
  s_cbranch_execz L_dryWx_29
  s_barrier
  s_cmp_lt_u32 s56, 4
  s_cbranch_scc1 L_gatherc_48
L_pW3_24:
  ds_read_b128 v[96:99], v129 offset:0
  ds_read_b128 v[100:103], v129 offset:64
  ds_read_b128 v[104:107], v129 offset:128
  ds_read_b128 v[108:111], v129 offset:192
  s_waitcnt lgkmcnt(3)
  v_mfma_f32_16x16x32_bf16 v[132:135], v[32:35], v[96:99], 0
  v_mfma_f32_16x16x32_bf16 v[136:139], v[148:151], v[96:99], 0
  s_waitcnt lgkmcnt(2)
  v_mfma_f32_16x16x32_bf16 v[132:135], v[36:39], v[100:103], v[132:135]
  v_mfma_f32_16x16x32_bf16 v[136:139], v[152:155], v[100:103], v[136:139]
  s_waitcnt lgkmcnt(1)
  v_mfma_f32_16x16x32_bf16 v[132:135], v[40:43], v[104:107], v[132:135]
  v_mfma_f32_16x16x32_bf16 v[136:139], v[156:159], v[104:107], v[136:139]
  s_waitcnt lgkmcnt(0)
  v_mfma_f32_16x16x32_bf16 v[132:135], v[44:47], v[108:111], v[132:135]
  v_mfma_f32_16x16x32_bf16 v[136:139], v[160:163], v[108:111], v[136:139]
  s_nop 7
  v_cndmask_b32 v132, v132, v136, s[100:101]
  v_cndmask_b32 v133, v133, v137, s[100:101]
  v_cndmask_b32 v134, v134, v138, s[100:101]
  v_cndmask_b32 v135, v135, v139, s[100:101]
  v_cvt_pk_bf16_f32 v136, v132, v133
  v_cvt_pk_bf16_f32 v137, v134, v135
  v_lshl_or_b32 v132, v136, 16, v13
  v_and_or_b32 v133, v136, s9, v13
  v_lshl_or_b32 v134, v137, 16, v13
  v_and_or_b32 v135, v137, s9, v13
  s_mov_b64 exec, s[98:99]
  s_cbranch_execz L_skipmem_3
  buffer_store_dwordx4 v[132:135], v8, s[48:51], s65 offen
  buffer_store_dwordx4 v[132:135], v8, s[48:51], s66 offen sc1
L_skipmem_3:
  s_mov_b64 exec, s[4:5]
  s_branch L_barc_49
L_gatherc_48:
L_pW4_25:
  s_mov_b32 s79, 4
L_fast_52:
  s_cbranch_execz L_skipmem_4
  buffer_load_dwordx4 v[80:83], v9, s[48:51], s65 offen sc1
L_skipmem_4:
  s_waitcnt vmcnt(0)
  v_bitop3_b32 v88, v80, v81, v13 bitop3:0x7e
  v_bitop3_b32 v88, v88, v82, v13 bitop3:0xf6
  v_bitop3_b32 v88, v88, v83, v13 bitop3:0xf6
  v_and_b32 v88, 0xff, v88
  v_cmp_ne_u32 vcc, 0, v88
  s_cbranch_vccz L_gok_51
  s_sub_u32 s79, s79, 1
  s_cmp_lg_u32 s79, 0
  s_cbranch_scc1 L_fast_52
L_look_50:
  s_cbranch_execz L_skipmem_5
  buffer_load_dwordx4 v[80:83], v9, s[48:51], s65 offen sc1
  buffer_load_dwordx4 v[84:87], v9, s[48:51], s66 offen sc1
L_skipmem_5:
  s_waitcnt vmcnt(1)
  v_bitop3_b32 v88, v80, v81, v13 bitop3:0x7e
  v_bitop3_b32 v88, v88, v82, v13 bitop3:0xf6
  v_bitop3_b32 v88, v88, v83, v13 bitop3:0xf6
  v_and_b32 v88, 0xff, v88
  v_cmp_ne_u32 vcc, 0, v88
  s_cbranch_vccz L_gok_51
  s_waitcnt vmcnt(0)
  v_bitop3_b32 v88, v84, v85, v13 bitop3:0x7e
  v_bitop3_b32 v88, v88, v86, v13 bitop3:0xf6
  v_bitop3_b32 v88, v88, v87, v13 bitop3:0xf6
  v_and_b32 v88, 0xff, v88
  v_cmp_ne_u32 vcc, 0, v88
  s_add_u32 s62, s62, 1
  s_cbranch_vccz L_pd_53
  s_cmp_lt_u32 s62, 400000
  s_cbranch_scc1 L_look_50
L_pd_53:
  v_mov_b32 v80, v84
  v_mov_b32 v81, v85
  v_mov_b32 v82, v86
  v_mov_b32 v83, v87
L_gok_51:
  v_perm_b32 v88, v81, v80, s16
  v_perm_b32 v89, v83, v82, s16
  ds_write_b64 v10, v[88:89]
L_barc_49:
  s_waitcnt lgkmcnt(0)
  s_cbranch_execz L_dryWx_29
  s_barrier
L_pW5_26:
  s_cmp_eq_u32 s56, 3
  s_cbranch_scc1 L_final_54
  ds_read_b128 v[92:95], v11 offset:0
  ds_read_b128 v[96:99], v11 offset:64
  ds_read_b128 v[100:103], v11 offset:128
  ds_read_b128 v[104:107], v11 offset:192
  s_cmp_lt_u32 s56, 4
  s_cbranch_scc0 L_p4one_56
  s_waitcnt lgkmcnt(3)
  v_mfma_f32_16x16x32_bf16 v[132:135], v[48:51], v[92:95], 0
  v_mfma_f32_16x16x32_bf16 v[136:139], v[64:67], v[92:95], 0
  s_waitcnt lgkmcnt(2)
  v_mfma_f32_16x16x32_bf16 v[132:135], v[52:55], v[96:99], v[132:135]
  v_mfma_f32_16x16x32_bf16 v[136:139], v[68:71], v[96:99], v[136:139]
  s_waitcnt lgkmcnt(1)
  v_mfma_f32_16x16x32_bf16 v[132:135], v[56:59], v[100:103], v[132:135]
  v_mfma_f32_16x16x32_bf16 v[136:139], v[72:75], v[100:103], v[136:139]
  s_waitcnt lgkmcnt(0)
  v_mfma_f32_16x16x32_bf16 v[132:135], v[60:63], v[104:107], v[132:135]
  v_mfma_f32_16x16x32_bf16 v[136:139], v[76:79], v[104:107], v[136:139]
  s_nop 7
  v_cndmask_b32 v132, v132, v136, s[100:101]
  v_cndmask_b32 v133, v133, v137, s[100:101]
  v_cndmask_b32 v134, v134, v138, s[100:101]
  v_cndmask_b32 v135, v135, v139, s[100:101]
  v_add_f32_dpp v132, v132, v132 row_ror:4 row_mask:0xf bank_mask:0xf
  v_add_f32_dpp v133, v133, v133 row_ror:4 row_mask:0xf bank_mask:0xf
  v_add_f32_dpp v134, v134, v134 row_ror:4 row_mask:0xf bank_mask:0xf
  v_add_f32_dpp v135, v135, v135 row_ror:4 row_mask:0xf bank_mask:0xf
  v_add_f32_dpp v132, v132, v132 row_ror:8 row_mask:0xf bank_mask:0xf
  v_add_f32_dpp v133, v133, v133 row_ror:8 row_mask:0xf bank_mask:0xf
  v_add_f32_dpp v134, v134, v134 row_ror:8 row_mask:0xf bank_mask:0xf
  v_add_f32_dpp v135, v135, v135 row_ror:8 row_mask:0xf bank_mask:0xf
  v_and_or_b32 v132, v132, s77, v13
  v_and_or_b32 v133, v133, s77, v13
  v_and_or_b32 v134, v134, s77, v13
  v_and_or_b32 v135, v135, s77, v13
  s_mov_b64 exec, s[98:99]
  s_cbranch_execz L_skipmem_6
  buffer_store_dwordx4 v[132:135], v130, s[48:51], 0 offen sc1
L_skipmem_6:
  s_mov_b64 exec, s[4:5]
  s_branch L_wdone_55
L_p4one_56:
  s_waitcnt lgkmcnt(3)
  v_mfma_f32_16x16x32_bf16 v[132:135], v[48:51], v[92:95], 0
  s_waitcnt lgkmcnt(2)
  v_mfma_f32_16x16x32_bf16 v[132:135], v[52:55], v[96:99], v[132:135]
  s_waitcnt lgkmcnt(1)
  v_mfma_f32_16x16x32_bf16 v[132:135], v[56:59], v[100:103], v[132:135]
  s_waitcnt lgkmcnt(0)
  v_mfma_f32_16x16x32_bf16 v[132:135], v[60:63], v[104:107], v[132:135]
  s_nop 7
  v_add_f32_dpp v132, v132, v132 row_ror:4 row_mask:0xf bank_mask:0xf
  v_add_f32_dpp v133, v133, v133 row_ror:4 row_mask:0xf bank_mask:0xf
  v_add_f32_dpp v134, v134, v134 row_ror:4 row_mask:0xf bank_mask:0xf
  v_add_f32_dpp v135, v135, v135 row_ror:4 row_mask:0xf bank_mask:0xf
  v_add_f32_dpp v132, v132, v132 row_ror:8 row_mask:0xf bank_mask:0xf
  v_add_f32_dpp v133, v133, v133 row_ror:8 row_mask:0xf bank_mask:0xf
  v_add_f32_dpp v134, v134, v134 row_ror:8 row_mask:0xf bank_mask:0xf
  v_add_f32_dpp v135, v135, v135 row_ror:8 row_mask:0xf bank_mask:0xf
  v_and_or_b32 v132, v132, s77, v13
  v_and_or_b32 v133, v133, s77, v13
  v_and_or_b32 v134, v134, s77, v13
  v_and_or_b32 v135, v135, s77, v13
  s_mov_b64 exec, s[70:71]
  s_cbranch_execz L_skipmem_7
  buffer_store_dwordx4 v[132:135], v130, s[48:51], 0 offen sc1
L_skipmem_7:
  s_mov_b64 exec, s[4:5]
  s_branch L_wdone_55
L_final_54:
L_pW6_27:
  s_cmp_lt_u32 s57, 10
  s_cbranch_scc0 L_wdone_55
  s_mul_i32 s63, s58, 10
  s_add_u32 s63, s63, s57
  s_lshl_b32 s63, s63, 13
  s_add_u32 s63, s63, 917504
  s_add_u32 s64, s63, 4096
L_pollG_57:
  v_mov_b32 v108, v13
  v_mov_b32 v109, v13
  v_mov_b32 v110, v13
  v_mov_b32 v111, v13
  s_cbranch_execz L_skipmem_8
  buffer_load_dwordx4 v[96:99], v142, s[48:51], s64 offen offset:0 sc1
  buffer_load_dwordx4 v[100:103], v142, s[48:51], s64 offen offset:1024 sc1
  buffer_load_dwordx4 v[104:107], v142, s[48:51], s64 offen offset:2048 sc1
L_skipmem_8:
  s_mov_b64 exec, s[22:23]
  s_cbranch_execz L_skipmem_9
  buffer_load_dwordx4 v[108:111], v142, s[48:51], s64 offen offset:3072 sc1
L_skipmem_9:
  s_mov_b64 exec, s[4:5]
  s_waitcnt vmcnt(0)
  v_xor_b32 v96, v96, v13
  v_xor_b32 v97, v97, v13
  v_xor_b32 v98, v98, v13
  v_xor_b32 v99, v99, v13
  v_xor_b32 v100, v100, v13
  v_xor_b32 v101, v101, v13
  v_xor_b32 v102, v102, v13
  v_xor_b32 v103, v103, v13
  v_xor_b32 v104, v104, v13
  v_xor_b32 v105, v105, v13
  v_xor_b32 v106, v106, v13
  v_xor_b32 v107, v107, v13
  v_xor_b32 v108, v108, v13
  v_xor_b32 v109, v109, v13
  v_xor_b32 v110, v110, v13
  v_xor_b32 v111, v111, v13
  v_or3_b32 v112, v96, v97, v98
  v_or3_b32 v112, v112, v99, v100
  v_or3_b32 v112, v112, v101, v102
  v_or3_b32 v112, v112, v103, v104
  v_or3_b32 v112, v112, v105, v106
  v_or3_b32 v112, v112, v107, v108
  v_or3_b32 v112, v112, v109, v110
  v_or_b32 v112, v112, v111
  v_and_b32 v112, 0xff, v112
  v_cmp_ne_u32 vcc, 0, v112
  s_add_u32 s62, s62, 1
  s_cbranch_vccz L_pd_58
  s_cmp_lt_u32 s62, 400000
  s_cbranch_scc1 L_pollG_57
L_pd_58:
  s_cbranch_execz L_skipmem_10
  buffer_load_dwordx4 v[80:83], v142, s[48:51], s63 offen offset:0 sc1
  buffer_load_dwordx4 v[84:87], v142, s[48:51], s63 offen offset:1024 sc1
  buffer_load_dwordx4 v[88:91], v142, s[48:51], s63 offen offset:2048 sc1
  buffer_load_dwordx4 v[92:95], v142, s[48:51], s63 offen offset:3072 sc1
L_skipmem_10:
  v_add_f32 v96, v96, v100
  v_add_f32 v104, v104, v108
  v_add_f32 v97, v97, v101
  v_add_f32 v105, v105, v109
  v_add_f32 v98, v98, v102
  v_add_f32 v106, v106, v110
  v_add_f32 v99, v99, v103
  v_add_f32 v107, v107, v111
  v_add_f32 v96, v96, v104
  v_add_f32 v97, v97, v105
  v_add_f32 v98, v98, v106
  v_add_f32 v99, v99, v107
  v_add_f32_dpp v96, v96, v96 row_ror:8 row_mask:0xf bank_mask:0xf
  v_add_f32_dpp v97, v97, v97 row_ror:8 row_mask:0xf bank_mask:0xf
  v_add_f32_dpp v98, v98, v98 row_ror:8 row_mask:0xf bank_mask:0xf
  v_add_f32_dpp v99, v99, v99 row_ror:8 row_mask:0xf bank_mask:0xf
  v_permlane16_swap_b32 v96, v97
  s_nop 0
  v_permlane16_swap_b32 v98, v99
  v_add_f32 v96, v96, v97
  v_add_f32 v98, v98, v99
  s_nop 1
  v_permlane32_swap_b32 v96, v98
  v_add_f32 v96, v96, v98
  v_cvt_pk_bf16_f32 v96, v96, v96
  v_and_b32 v96, 0xffff0000, v96
  v_mul_f32 v112, 0xbfb8aa3b, v96
  v_exp_f32 v112, v112
  s_nop 0
  v_add_f32 v112, 1.0, v112
  v_rcp_f32 v112, v112
  s_nop 0
  v_mul_f32 v96, v96, v112
  v_cvt_pk_bf16_f32 v96, v96, v96
  v_and_b32 v96, 0xffff0000, v96
  s_cbranch_execz L_dryWx_29
L_pW7_28:
  v_lshlrev_b32 v100, 16, v144
  s_waitcnt vmcnt(0)
  v_xor_b32 v80, v80, v13
  v_xor_b32 v81, v81, v13
  v_xor_b32 v82, v82, v13
  v_xor_b32 v83, v83, v13
  v_xor_b32 v84, v84, v13
  v_xor_b32 v85, v85, v13
  v_xor_b32 v86, v86, v13
  v_xor_b32 v87, v87, v13
  v_xor_b32 v88, v88, v13
  v_xor_b32 v89, v89, v13
  v_xor_b32 v90, v90, v13
  v_xor_b32 v91, v91, v13
  v_xor_b32 v92, v92, v13
  v_xor_b32 v93, v93, v13
  v_xor_b32 v94, v94, v13
  v_xor_b32 v95, v95, v13
  v_or3_b32 v112, v80, v81, v82
  v_or3_b32 v112, v112, v83, v84
  v_or3_b32 v112, v112, v85, v86
  v_or3_b32 v112, v112, v87, v88
  v_or3_b32 v112, v112, v89, v90
  v_or3_b32 v112, v112, v91, v92
  v_or3_b32 v112, v112, v93, v94
  v_or_b32 v112, v112, v95
  v_and_b32 v112, 0xff, v112
  v_cmp_ne_u32 vcc, 0, v112
  s_cbranch_vccz L_fok_60
L_pollF_59:
  s_cbranch_execz L_skipmem_11
  buffer_load_dwordx4 v[80:83], v142, s[48:51], s63 offen offset:0 sc1
  buffer_load_dwordx4 v[84:87], v142, s[48:51], s63 offen offset:1024 sc1
  buffer_load_dwordx4 v[88:91], v142, s[48:51], s63 offen offset:2048 sc1
  buffer_load_dwordx4 v[92:95], v142, s[48:51], s63 offen offset:3072 sc1
L_skipmem_11:
  s_waitcnt vmcnt(0)
  v_xor_b32 v80, v80, v13
  v_xor_b32 v81, v81, v13
  v_xor_b32 v82, v82, v13
  v_xor_b32 v83, v83, v13
  v_xor_b32 v84, v84, v13
  v_xor_b32 v85, v85, v13
  v_xor_b32 v86, v86, v13
  v_xor_b32 v87, v87, v13
  v_xor_b32 v88, v88, v13
  v_xor_b32 v89, v89, v13
  v_xor_b32 v90, v90, v13
  v_xor_b32 v91, v91, v13
  v_xor_b32 v92, v92, v13
  v_xor_b32 v93, v93, v13
  v_xor_b32 v94, v94, v13
  v_xor_b32 v95, v95, v13
  v_or3_b32 v112, v80, v81, v82
  v_or3_b32 v112, v112, v83, v84
  v_or3_b32 v112, v112, v85, v86
  v_or3_b32 v112, v112, v87, v88
  v_or3_b32 v112, v112, v89, v90
  v_or3_b32 v112, v112, v91, v92
  v_or3_b32 v112, v112, v93, v94
  v_or_b32 v112, v112, v95
  v_and_b32 v112, 0xff, v112
  v_cmp_ne_u32 vcc, 0, v112
  s_add_u32 s62, s62, 1
  s_cbranch_vccz L_pd_61
  s_cmp_lt_u32 s62, 400000
  s_cbranch_scc1 L_pollF_59
L_pd_61:
L_fok_60:
  v_add_f32 v80, v80, v84
  v_add_f32 v88, v88, v92
  v_add_f32 v81, v81, v85
  v_add_f32 v89, v89, v93
  v_add_f32 v82, v82, v86
  v_add_f32 v90, v90, v94
  v_add_f32 v83, v83, v87
  v_add_f32 v91, v91, v95
  v_add_f32 v80, v80, v88
  v_add_f32 v81, v81, v89
  v_add_f32 v82, v82, v90
  v_add_f32 v83, v83, v91
  v_add_f32_dpp v80, v80, v80 row_ror:8 row_mask:0xf bank_mask:0xf
  v_add_f32_dpp v81, v81, v81 row_ror:8 row_mask:0xf bank_mask:0xf
  v_add_f32_dpp v82, v82, v82 row_ror:8 row_mask:0xf bank_mask:0xf
  v_add_f32_dpp v83, v83, v83 row_ror:8 row_mask:0xf bank_mask:0xf
  v_permlane16_swap_b32 v80, v81
  s_nop 0
  v_permlane16_swap_b32 v82, v83
  v_add_f32 v80, v80, v81
  v_add_f32 v82, v82, v83
  s_nop 1
  v_permlane32_swap_b32 v80, v82
  v_add_f32 v80, v80, v82
  v_cvt_pk_bf16_f32 v80, v80, v80
  v_and_b32 v80, 0xffff0000, v80
  v_mul_f32 v80, v80, v96
  v_cvt_pk_bf16_f32 v80, v80, v80
  v_and_b32 v80, 0xffff0000, v80
  v_add_f32 v80, v80, v100
  v_cvt_pk_bf16_f32 v80, v80, v80
  s_mov_b64 exec, s[18:19]
  s_cbranch_execz L_skipmem_12
  buffer_store_short v80, v146, s[52:55], 0 offen
L_skipmem_12:
  s_or_b32 s63, s57, s58
  s_cmp_eq_u32 s63, 0
  s_cbranch_scc0 L_noep_62
  v_mov_b32 v113, s60
  s_mov_b64 exec, s[20:21]
  s_cbranch_execz L_skipmem_13
  buffer_store_dword v113, v147, s[48:51], 0 offen offset:0
L_skipmem_13:
L_noep_62:
  s_mov_b64 exec, s[4:5]
L_wdone_55:
  s_cbranch_execz L_dryWx_29
  s_endpgm
L_roleA:
  s_load_dwordx2 s[32:33], s[0:1], 8
  s_mov_b32 s34, 8388608
  s_mov_b32 s35, 0x00020000
  s_load_dwordx2 s[36:37], s[0:1], 56
  s_mov_b32 s38, 2211840
  s_mov_b32 s39, 0x00020000
  s_load_dwordx2 s[40:41], s[0:1], 64
  s_mov_b32 s42, 2211840
  s_mov_b32 s43, 0x00020000
  s_sub_u32 s63, s2, 128
  s_lshr_b32 s57, s63, 6
  s_lshr_b32 s58, s63, 5
  s_and_b32 s58, s58, 1
  s_and_b32 s59, s63, 31
  s_lshr_b32 s68, s63, 5
  s_lshl_b32 s68, s68, 3
  s_and_b32 s64, s63, 7
  s_or_b32 s68, s68, s64
  s_lshr_b32 s69, s63, 3
  s_and_b32 s69, s69, 3
  v_lshlrev_b32 v4, 4, v1
  s_lshl_b32 s63, s58, 12
  s_lshl_b32 s64, s59, 7
  s_add_u32 s63, s63, s64
  s_lshl_b32 s64, s56, 2
  s_add_u32 s63, s63, s64
  s_lshl_b32 s66, s63, 10
  s_mul_i32 s67, s56, 4224
  s_lshl_b32 s63, s57, 16
  s_add_u32 s66, s66, s63
  s_mul_i32 s78, s57, 131072
  s_sub_u32 s78, 29696, s78
  s_waitcnt lgkmcnt(0)
  s_load_dword s60, s[48:49], 0
  s_cmp_lt_u32 s56, 2
  s_cbranch_scc0 L_nox_63
  s_mul_i32 s63, s56, 1280
  v_mul_u32_u24 v45, 20, v1
  v_add_u32 v45, s63, v45
  buffer_load_dwordx4 v[40:43], v45, s[28:31], 0 offen
  buffer_load_dword v44, v45, s[28:31], 0 offen offset:16
L_nox_63:
  s_cmp_eq_u32 s56, 3
  s_cbranch_scc0 L_atouch_64
  s_sub_u32 s63, s2, 128
  s_and_b32 s64, s63, 7
  s_lshr_b32 s63, s63, 3
  s_lshl_b32 s63, s63, 4
  v_and_b32 v24, 15, v1
  v_add_u32 v24, s63, v24
  v_bfe_u32 v25, v24, 5, 2
  v_lshlrev_b32 v25, 3, v25
  v_add_u32 v25, s64, v25
  v_lshlrev_b32 v25, 12, v25
  v_and_b32 v26, 31, v24
  v_lshl_add_u32 v25, v26, 7, v25
  v_lshrrev_b32 v26, 7, v24
  v_lshlrev_b32 v26, 18, v26
  v_add_u32 v25, v25, v26
  v_add_u32 v25, 65536, v25
  s_mov_b64 exec, 0xffff
  buffer_load_dword v129, v25, s[48:51], 0 offen
  s_mov_b64 exec, -1
L_atouch_64:
  v_mov_b32 v48, 0
  v_mov_b32 v19, 0
  v_mov_b32 v18, 0
  v_mov_b32 v49, 0
  v_mov_b32 v50, 0
  v_mov_b32 v51, 0
  v_mov_b32 v52, 0
  v_mov_b32 v53, 0
  s_mov_b64 s[4:5], 0
  s_mov_b64 s[70:71], 0
  s_mov_b64 s[72:73], 0
  s_mov_b64 s[6:7], 0
  s_mov_b64 s[18:19], 0
  s_mov_b64 s[20:21], 0
  s_mov_b64 s[22:23], 0
  s_mov_b64 s[98:99], 0
  s_mov_b64 exec, s[4:5]
  s_mov_b32 s26, s56
  s_cmp_eq_u32 s26, 0
  s_cbranch_scc0 L_dj_73
  s_mov_b32 s56, 0
  s_branch L_pA0_65
L_dj_73:
  s_cmp_eq_u32 s26, 1
  s_cbranch_scc0 L_dj_74
  s_mov_b32 s56, 0
  s_branch L_pA1_66
L_dj_74:
  s_cmp_eq_u32 s26, 2
  s_cbranch_scc0 L_dj_75
  s_mov_b32 s56, 0
  s_branch L_pA2_67
L_dj_75:
  s_cmp_eq_u32 s26, 3
  s_cbranch_scc0 L_dj_76
  s_mov_b32 s56, 1
  s_branch L_pA3_68
L_dj_76:
  s_cmp_eq_u32 s26, 4
  s_cbranch_scc0 L_dj_77
  s_mov_b32 s56, 0
  s_branch L_pA4_69
L_dj_77:
  s_cmp_eq_u32 s26, 5
  s_cbranch_scc0 L_dj_78
  s_mov_b32 s56, 0
  s_branch L_pA5_70
L_dj_78:
  s_cmp_eq_u32 s26, 6
  s_cbranch_scc0 L_dj_79
  s_mov_b32 s56, 0
  s_branch L_pA6_71
L_dj_79:
  s_branch L_dryAx_72
L_dryAx_72:
  s_mov_b32 s56, s26
  s_mov_b32 s4, 0xffffffff
  s_mov_b32 s5, 0xffffffff
  s_mov_b32 s70, 0x30003
  s_mov_b32 s71, 0x30003
  s_mov_b32 s72, 0xffffffff
  s_mov_b32 s73, 0x0
  s_mov_b32 s6, 0xffff
  s_mov_b32 s7, 0x0
  s_mov_b32 s18, 0xff00ff
  s_mov_b32 s19, 0xff00ff
  s_mov_b32 s20, 0x1
  s_mov_b32 s21, 0x0
  s_mov_b32 s22, 0xffffff
  s_mov_b32 s23, 0x0
  s_mov_b32 s98, 0xf000f
  s_mov_b32 s99, 0xf000f
  s_mov_b64 exec, s[4:5]
  s_cmp_lt_u32 s56, 2
  s_cbranch_scc0 L_noln0_80
  s_waitcnt vmcnt(0)
  v_lshlrev_b32 v24, 16, v40
  v_and_b32 v25, 0xffff0000, v40
  v_lshlrev_b32 v26, 16, v41
  v_and_b32 v27, 0xffff0000, v41
  v_lshlrev_b32 v28, 16, v42
  v_and_b32 v29, 0xffff0000, v42
  v_lshlrev_b32 v30, 16, v43
  v_and_b32 v31, 0xffff0000, v43
  v_lshlrev_b32 v32, 16, v44
  v_and_b32 v33, 0xffff0000, v44
  v_add_f32 v34, v24, v25
  v_add_f32 v35, v26, v27
  v_add_f32 v36, v28, v29
  v_add_f32 v37, v30, v31
  v_add_f32 v34, v34, v35
  v_add_f32 v36, v36, v37
  v_add_f32 v35, v32, v33
  v_add_f32 v34, v34, v36
  v_add_f32 v34, v34, v35
  s_nop 1
  v_add_f32_dpp v34, v34, v34 row_ror:1 row_mask:0xf bank_mask:0xf
  s_nop 1
  v_add_f32_dpp v34, v34, v34 row_ror:2 row_mask:0xf bank_mask:0xf
  s_nop 1
  v_add_f32_dpp v34, v34, v34 row_ror:4 row_mask:0xf bank_mask:0xf
  s_nop 1
  v_add_f32_dpp v34, v34, v34 row_ror:8 row_mask:0xf bank_mask:0xf
  v_mov_b32 v35, v34
  s_nop 1
  v_permlane16_swap_b32 v34, v35
  v_add_f32 v34, v34, v35
  v_mov_b32 v35, v34
  s_nop 1
  v_permlane32_swap_b32 v34, v35
  v_add_f32 v34, v34, v35
  v_mul_f32 v36, 0x3acccccd, v34
  v_sub_f32 v35, v24, v36
  v_mul_f32 v34, v35, v35
  v_sub_f32 v35, v25, v36
  v_fmac_f32 v34, v35, v35
  v_sub_f32 v35, v26, v36
  v_fmac_f32 v34, v35, v35
  v_sub_f32 v35, v27, v36
  v_fmac_f32 v34, v35, v35
  v_sub_f32 v35, v28, v36
  v_fmac_f32 v34, v35, v35
  v_sub_f32 v35, v29, v36
  v_fmac_f32 v34, v35, v35
  v_sub_f32 v35, v30, v36
  v_fmac_f32 v34, v35, v35
  v_sub_f32 v35, v31, v36
  v_fmac_f32 v34, v35, v35
  v_sub_f32 v35, v32, v36
  v_fmac_f32 v34, v35, v35
  v_sub_f32 v35, v33, v36
  v_fmac_f32 v34, v35, v35
  s_nop 1
  v_add_f32_dpp v34, v34, v34 row_ror:1 row_mask:0xf bank_mask:0xf
  s_nop 1
  v_add_f32_dpp v34, v34, v34 row_ror:2 row_mask:0xf bank_mask:0xf
  s_nop 1
  v_add_f32_dpp v34, v34, v34 row_ror:4 row_mask:0xf bank_mask:0xf
  s_nop 1
  v_add_f32_dpp v34, v34, v34 row_ror:8 row_mask:0xf bank_mask:0xf
  v_mov_b32 v35, v34
  s_nop 1
  v_permlane16_swap_b32 v34, v35
  v_add_f32 v34, v34, v35
  v_mov_b32 v35, v34
  s_nop 1
  v_permlane32_swap_b32 v34, v35
  v_add_f32 v34, v34, v35
  v_cvt_pk_bf16_f32 v37, v36, v36
  v_and_b32 v37, 0xffff0000, v37
  v_mul_f32 v34, 0x3acccccd, v34
  v_cvt_pk_bf16_f32 v34, v34, v34
  v_and_b32 v34, 0xffff0000, v34
  v_add_f32 v34, 0x3727c5ac, v34
  v_cvt_pk_bf16_f32 v34, v34, v34
  v_and_b32 v34, 0xffff0000, v34
  v_sqrt_f32 v34, v34
  v_sub_f32 v24, v24, v37
  v_sub_f32 v25, v25, v37
  v_sub_f32 v26, v26, v37
  v_sub_f32 v27, v27, v37
  v_sub_f32 v28, v28, v37
  v_sub_f32 v29, v29, v37
  v_sub_f32 v30, v30, v37
  v_sub_f32 v31, v31, v37
  v_sub_f32 v32, v32, v37
  v_sub_f32 v33, v33, v37
  v_cvt_pk_bf16_f32 v34, v34, v34
  v_and_b32 v34, 0xffff0000, v34
  v_rcp_f32 v34, v34
  v_cvt_pk_bf16_f32 v40, v24, v25
  v_cvt_pk_bf16_f32 v41, v26, v27
  v_cvt_pk_bf16_f32 v42, v28, v29
  v_cvt_pk_bf16_f32 v43, v30, v31
  v_cvt_pk_bf16_f32 v44, v32, v33
  v_lshlrev_b32 v24, 16, v40
  v_and_b32 v25, 0xffff0000, v40
  v_lshlrev_b32 v26, 16, v41
  v_and_b32 v27, 0xffff0000, v41
  v_lshlrev_b32 v28, 16, v42
  v_and_b32 v29, 0xffff0000, v42
  v_lshlrev_b32 v30, 16, v43
  v_and_b32 v31, 0xffff0000, v43
  v_lshlrev_b32 v32, 16, v44
  v_and_b32 v33, 0xffff0000, v44
  v_mul_f32 v24, v24, v34
  v_mul_f32 v25, v25, v34
  v_mul_f32 v26, v26, v34
  v_mul_f32 v27, v27, v34
  v_mul_f32 v28, v28, v34
  v_mul_f32 v29, v29, v34
  v_mul_f32 v30, v30, v34
  v_mul_f32 v31, v31, v34
  v_mul_f32 v32, v32, v34
  v_mul_f32 v33, v33, v34
  v_add_u32 v35, 157184, v45
  v_cvt_pk_bf16_f32 v40, v24, v25
  ds_write_b32 v35, v40 offset:0
  v_cvt_pk_bf16_f32 v41, v26, v27
  ds_write_b32 v35, v41 offset:4
  v_cvt_pk_bf16_f32 v42, v28, v29
  ds_write_b32 v35, v42 offset:8
  v_cvt_pk_bf16_f32 v43, v30, v31
  ds_write_b32 v35, v43 offset:12
  v_cvt_pk_bf16_f32 v44, v32, v33
  ds_write_b32 v35, v44 offset:16
L_noln0_80:
  s_waitcnt lgkmcnt(0)
  s_barrier
  s_waitcnt lgkmcnt(0)
  s_add_u32 s60, s60, 1
  s_and_b32 s61, s60, 0xff
  v_mov_b32 v9, s61
  s_mov_b32 s16, 0x07060302
  s_mov_b32 s8, 0x10001
  s_mov_b32 s9, 0xffff0000
  s_mul_i32 s63, s56, 16896
  v_mul_u32_u24 v8, 1056, v2
  v_lshl_add_u32 v8, v3, 4, v8
  v_add_u32 v5, s63, v8
  v_add_u32 v8, 135168, v8
  v_lshrrev_b32 v10, 2, v2
  v_lshl_add_u32 v10, v3, 2, v10
  v_mul_u32_u24 v6, 1056, v10
  v_and_b32 v10, 3, v2
  v_lshl_add_u32 v6, v10, 3, v6
  s_lshl_b32 s63, s56, 7
  v_add_u32 v6, s63, v6
  v_add_u32 v7, 67584, v6
  s_lshl_b32 s63, s58, 5
  s_lshl_b32 s64, s57, 4
  s_add_u32 s63, s63, s64
  s_lshl_b32 s64, s56, 1
  s_add_u32 s63, s63, s64
  s_lshl_b32 s63, s63, 11
  s_add_u32 s63, s63, 589824
  v_add_u32 v12, s63, v4
  s_mul_i32 s63, s56, 2112
  s_add_u32 s63, s63, 135168
  v_lshlrev_b32 v13, 3, v1
  v_add_u32 v13, s63, v13
  v_lshlrev_b32 v15, 5, v2
  v_add_u32 v15, 156160, v15
  s_lshl_b32 s63, s56, 2
  v_add_u32 v14, s63, v15
  s_lshr_b32 s63, s56, 1
  s_lshl_b32 s63, s63, 10
  s_and_b32 s64, s56, 1
  s_lshl_b32 s64, s64, 3
  s_add_u32 s63, s63, s64
  v_add_u32 v17, 152064, v4
  v_add_u32 v16, s63, v17
  s_mov_b32 s76, 4096
  s_lshl_b32 s63, s57, 6
  s_lshr_b32 s64, s56, 1
  s_add_u32 s63, s63, s64
  s_lshl_b32 s63, s63, 14
  s_lshl_b32 s64, s58, 5
  s_add_u32 s64, s64, s59
  s_lshl_b32 s65, s64, 8
  s_add_u32 s63, s63, s65
  s_and_b32 s64, s56, 1
  s_lshl_b32 s64, s64, 7
  s_add_u32 s63, s63, s64
  s_add_u32 s63, s63, 1310720
  v_and_b32 v10, 7, v2
  v_lshlrev_b32 v18, 16, v10
  v_lshrrev_b32 v10, 3, v2
  v_lshl_add_u32 v18, v10, 6, v18
  v_and_b32 v10, 1, v3
  v_lshl_add_u32 v18, v10, 5, v18
  v_lshrrev_b32 v10, 1, v3
  v_lshl_add_u32 v18, v10, 4, v18
  v_add_u32 v18, s63, v18
  s_lshl_b32 s63, s57, 13
  s_lshr_b32 s65, s65, 1
  s_add_u32 s63, s63, s65
  s_add_u32 s63, s63, 851968
  v_lshlrev_b32 v19, 3, v2
  v_add_u32 v19, s63, v19
  v_add_u32 v32, 0, v1
  v_mul_u32_u24 v33, 3277, v32
  v_lshrrev_b32 v33, 16, v33
  v_mul_u32_u24 v49, 20, v33
  v_sub_u32 v32, v32, v49
  v_mul_u32_u24 v49, 1280, v33
  v_lshl_add_u32 v49, v32, 4, v49
  v_add_u32 v32, 64, v1
  v_mul_u32_u24 v33, 3277, v32
  v_lshrrev_b32 v33, 16, v33
  v_mul_u32_u24 v50, 20, v33
  v_sub_u32 v32, v32, v50
  v_mul_u32_u24 v50, 1280, v33
  v_lshl_add_u32 v50, v32, 4, v50
  v_add_u32 v32, 128, v1
  v_mul_u32_u24 v33, 3277, v32
  v_lshrrev_b32 v33, 16, v33
  v_mul_u32_u24 v51, 20, v33
  v_sub_u32 v32, v32, v51
  v_mul_u32_u24 v51, 1280, v33
  v_lshl_add_u32 v51, v32, 4, v51
  v_add_u32 v32, 192, v1
  v_mul_u32_u24 v33, 3277, v32
  v_lshrrev_b32 v33, 16, v33
  v_mul_u32_u24 v52, 20, v33
  v_sub_u32 v32, v32, v52
  v_mul_u32_u24 v52, 1280, v33
  v_lshl_add_u32 v52, v32, 4, v52
  v_add_u32 v32, 256, v1
  v_mul_u32_u24 v33, 3277, v32
  v_lshrrev_b32 v33, 16, v33
  v_mul_u32_u24 v53, 20, v33
  v_sub_u32 v32, v32, v53
  v_mul_u32_u24 v53, 1280, v33
  v_lshl_add_u32 v53, v32, 4, v53
  v_lshrrev_b32 v10, 3, v1
  v_bfe_u32 v11, v10, 1, 1
  s_and_b32 s63, s56, 1
  s_lshl_b32 s63, s63, 1
  v_or_b32 v11, s63, v11
  v_lshlrev_b32 v11, 1, v11
  v_and_b32 v48, 7, v1
  v_xor_b32 v48, v48, v11
  v_lshlrev_b32 v48, 4, v48
  v_mul_u32_u24 v10, 3456, v10
  v_add_u32 v48, v48, v10
  v_and_b32 v26, 1, v3
  v_lshrrev_b32 v27, 1, v3
  v_lshl_or_b32 v26, v26, 1, v27
  s_and_b32 s63, s56, 1
  s_lshl_b32 s63, s63, 3
  v_or_b32 v26, s63, v26
  v_add_u32 v27, 4, v26
  v_mul_u32_u24 v28, 0x9d, v26
  v_add_u32 v28, 0x35, v28
  v_xor_b32 v28, s61, v28
  v_bfe_u32 v29, v28, 1, 1
  v_bfe_u32 v0, v28, 0, 1
  v_lshl_or_b32 v0, v29, 16, v0
  v_bfe_u32 v29, v28, 3, 1
  v_bfe_u32 v20, v28, 2, 1
  v_lshl_or_b32 v20, v29, 16, v20
  v_bfe_u32 v29, v28, 5, 1
  v_bfe_u32 v21, v28, 4, 1
  v_lshl_or_b32 v21, v29, 16, v21
  v_bfe_u32 v29, v28, 7, 1
  v_bfe_u32 v22, v28, 6, 1
  v_lshl_or_b32 v22, v29, 16, v22
  v_mul_u32_u24 v28, 0x9d, v27
  v_add_u32 v28, 0x35, v28
  v_xor_b32 v28, s61, v28
  v_bfe_u32 v29, v28, 1, 1
  v_bfe_u32 v23, v28, 0, 1
  v_lshl_or_b32 v23, v29, 16, v23
  v_bfe_u32 v29, v28, 3, 1
  v_bfe_u32 v62, v28, 2, 1
  v_lshl_or_b32 v62, v29, 16, v62
  v_bfe_u32 v29, v28, 5, 1
  v_bfe_u32 v63, v28, 4, 1
  v_lshl_or_b32 v63, v29, 16, v63
  v_bfe_u32 v29, v28, 7, 1
  v_bfe_u32 v10, v28, 6, 1
  v_lshl_or_b32 v10, v29, 16, v10
  v_xor_b32 v64, 1, v9
  v_mov_b32 v65, v64
  v_mov_b32 v66, v64
  v_mov_b32 v67, v64
  s_mov_b32 s63, 65536
  s_mov_b32 s64, 16384
  s_mov_b64 exec, s[70:71]
  s_cmp_eq_u32 s56, 7
  s_cbranch_scc0 L_pwc_81
  s_mov_b64 exec, 0xffff
  v_xor_b32 v65, 1, v65
  v_mov_b32 v65, s60
  v_xor_b32 v65, 1, v65
  buffer_store_dwordx2 v[64:65], v19, s[48:51], 0 offen sc1
  buffer_store_dwordx2 v[64:65], v19, s[48:51], s64 offen sc1
L_pwc_81:
  s_mov_b64 exec, s[4:5]
  s_mov_b32 m0, s67
  s_add_u32 s67, s67, 1056
  buffer_load_dwordx4 v4, s[32:35], s66 offen  lds
  s_add_u32 s66, s66, 1024
  s_mov_b32 m0, s67
  s_add_u32 s67, s67, 1056
  buffer_load_dwordx4 v4, s[32:35], s66 offen  lds
  s_add_u32 s66, s66, 1024
  s_mov_b32 m0, s67
  s_add_u32 s67, s67, 1056
  buffer_load_dwordx4 v4, s[32:35], s66 offen  lds
  s_add_u32 s66, s66, 1024
  s_mov_b32 m0, s67
  s_add_u32 s67, s67, 30624
  buffer_load_dwordx4 v4, s[32:35], s66 offen  lds
  s_add_u32 s66, s66, 29696
  s_barrier
  s_mov_b32 m0, s67
  s_add_u32 s67, s67, 1056
  buffer_load_dwordx4 v4, s[32:35], s66 offen  lds
  s_add_u32 s66, s66, 1024
  s_mov_b32 m0, s67
  s_add_u32 s67, s67, 1056
  buffer_load_dwordx4 v4, s[32:35], s66 offen  lds
  s_add_u32 s66, s66, 1024
  s_mov_b32 m0, s67
  s_add_u32 s67, s67, 1056
  buffer_load_dwordx4 v4, s[32:35], s66 offen  lds
  s_add_u32 s66, s66, 1024
  s_mov_b32 m0, s67
  s_add_u32 s67, s67, 30624
  buffer_load_dwordx4 v4, s[32:35], s66 offen  lds
  s_add_u32 s66, s66, s78
  s_waitcnt vmcnt(4) lgkmcnt(0)
  s_barrier
  s_mov_b32 m0, s67
  s_add_u32 s67, s67, 1056
  buffer_load_dwordx4 v4, s[32:35], s66 offen  lds
  s_add_u32 s66, s66, 1024
  s_mov_b32 m0, s67
  s_add_u32 s67, s67, 1056
  buffer_load_dwordx4 v4, s[32:35], s66 offen  lds
  s_add_u32 s66, s66, 1024
  s_mov_b32 m0, s67
  s_add_u32 s67, s67, 1056
  buffer_load_dwordx4 v4, s[32:35], s66 offen  lds
  s_add_u32 s66, s66, 1024
  s_mov_b32 m0, s67
  s_add_u32 s67, s67, 30624
  buffer_load_dwordx4 v4, s[32:35], s66 offen  lds
  s_add_u32 s66, s66, 29696
  s_lshr_b32 s63, s56, 1
  s_cmp_eq_u32 s63, 0
  s_cbranch_scc0 L_noqk_82
  ds_read_b128 v[128:131], v5 offset:0
  ds_read_b128 v[132:135], v5 offset:64
  ds_read_b128 v[136:139], v5 offset:128
  ds_read_b128 v[140:143], v5 offset:192
  ds_read_b128 v[144:147], v5 offset:256
  ds_read_b128 v[148:151], v5 offset:320
  ds_read_b128 v[152:155], v5 offset:384
  ds_read_b128 v[156:159], v5 offset:448
  ds_read_b128 v[160:163], v5 offset:512
  ds_read_b128 v[164:167], v5 offset:576
  ds_read_b128 v[168:171], v5 offset:640
  ds_read_b128 v[172:175], v5 offset:704
  ds_read_b128 v[176:179], v5 offset:768
  ds_read_b128 v[180:183], v5 offset:832
  ds_read_b128 v[184:187], v5 offset:896
  ds_read_b128 v[188:191], v5 offset:960
L_noqk_82:
  ds_read_b64_tr_b16 v[192:193], v6 offset:0
  ds_read_b64_tr_b16 v[194:195], v6 offset:16896
  ds_read_b64_tr_b16 v[208:209], v6 offset:32
  ds_read_b64_tr_b16 v[210:211], v6 offset:16928
  ds_read_b64_tr_b16 v[224:225], v6 offset:64
  ds_read_b64_tr_b16 v[226:227], v6 offset:16960
  ds_read_b64_tr_b16 v[240:241], v6 offset:96
  ds_read_b64_tr_b16 v[242:243], v6 offset:16992
  s_waitcnt vmcnt(4) lgkmcnt(0)
  s_barrier
  s_mov_b32 m0, s67
  s_add_u32 s67, s67, 1056
  buffer_load_dwordx4 v4, s[32:35], s66 offen  lds
  s_add_u32 s66, s66, 1024
  s_mov_b32 m0, s67
  s_add_u32 s67, s67, 1056
  buffer_load_dwordx4 v4, s[32:35], s66 offen  lds
  s_add_u32 s66, s66, 1024
  s_mov_b32 m0, s67
  s_add_u32 s67, s67, 1056
  buffer_load_dwordx4 v4, s[32:35], s66 offen  lds
  s_add_u32 s66, s66, 1024
  s_mov_b32 m0, s67
  s_nop 0
  buffer_load_dwordx4 v4, s[32:35], s66 offen  lds
  s_lshr_b32 s63, s56, 1
  s_cmp_eq_u32 s63, 1
  s_cbranch_scc0 L_noqk_83
  ds_read_b128 v[128:131], v5 offset:0
  ds_read_b128 v[132:135], v5 offset:64
  ds_read_b128 v[136:139], v5 offset:128
  ds_read_b128 v[140:143], v5 offset:192
  ds_read_b128 v[144:147], v5 offset:256
  ds_read_b128 v[148:151], v5 offset:320
  ds_read_b128 v[152:155], v5 offset:384
  ds_read_b128 v[156:159], v5 offset:448
  ds_read_b128 v[160:163], v5 offset:512
  ds_read_b128 v[164:167], v5 offset:576
  ds_read_b128 v[168:171], v5 offset:640
  ds_read_b128 v[172:175], v5 offset:704
  ds_read_b128 v[176:179], v5 offset:768
  ds_read_b128 v[180:183], v5 offset:832
  ds_read_b128 v[184:187], v5 offset:896
  ds_read_b128 v[188:191], v5 offset:960
L_noqk_83:
  ds_read_b64_tr_b16 v[196:197], v6 offset:33792
  ds_read_b64_tr_b16 v[198:199], v6 offset:50688
  ds_read_b64_tr_b16 v[212:213], v6 offset:33824
  ds_read_b64_tr_b16 v[214:215], v6 offset:50720
  ds_read_b64_tr_b16 v[228:229], v6 offset:33856
  ds_read_b64_tr_b16 v[230:231], v6 offset:50752
  ds_read_b64_tr_b16 v[244:245], v6 offset:33888
  ds_read_b64_tr_b16 v[246:247], v6 offset:50784
  s_waitcnt vmcnt(4) lgkmcnt(0)
  s_barrier
  s_lshr_b32 s63, s56, 1
  s_cmp_eq_u32 s63, 2
  s_cbranch_scc0 L_noqk_84
  ds_read_b128 v[128:131], v5 offset:0
  ds_read_b128 v[132:135], v5 offset:64
  ds_read_b128 v[136:139], v5 offset:128
  ds_read_b128 v[140:143], v5 offset:192
  ds_read_b128 v[144:147], v5 offset:256
  ds_read_b128 v[148:151], v5 offset:320
  ds_read_b128 v[152:155], v5 offset:384
  ds_read_b128 v[156:159], v5 offset:448
  ds_read_b128 v[160:163], v5 offset:512
  ds_read_b128 v[164:167], v5 offset:576
  ds_read_b128 v[168:171], v5 offset:640
  ds_read_b128 v[172:175], v5 offset:704
  ds_read_b128 v[176:179], v5 offset:768
  ds_read_b128 v[180:183], v5 offset:832
  ds_read_b128 v[184:187], v5 offset:896
  ds_read_b128 v[188:191], v5 offset:960
L_noqk_84:
  ds_read_b64_tr_b16 v[200:201], v7 offset:0
  ds_read_b64_tr_b16 v[202:203], v7 offset:16896
  ds_read_b64_tr_b16 v[216:217], v7 offset:32
  ds_read_b64_tr_b16 v[218:219], v7 offset:16928
  ds_read_b64_tr_b16 v[232:233], v7 offset:64
  ds_read_b64_tr_b16 v[234:235], v7 offset:16960
  ds_read_b64_tr_b16 v[248:249], v7 offset:96
  ds_read_b64_tr_b16 v[250:251], v7 offset:16992
  buffer_load_dwordx4 v[32:35], v12, s[48:51], 0 offen offset:0 sc1
  buffer_load_dwordx4 v[36:39], v12, s[48:51], 0 offen offset:1024 sc1
  buffer_load_dwordx4 v[40:43], v12, s[48:51], 0 offen offset:2048 sc1
  buffer_load_dwordx4 v[44:47], v12, s[48:51], 0 offen offset:3072 sc1
  s_waitcnt vmcnt(4) lgkmcnt(0)
  s_barrier
  s_lshr_b32 s63, s56, 1
  s_cmp_eq_u32 s63, 3
  s_cbranch_scc0 L_noqk_85
  ds_read_b128 v[128:131], v5 offset:0
  ds_read_b128 v[132:135], v5 offset:64
  ds_read_b128 v[136:139], v5 offset:128
  ds_read_b128 v[140:143], v5 offset:192
  ds_read_b128 v[144:147], v5 offset:256
  ds_read_b128 v[148:151], v5 offset:320
  ds_read_b128 v[152:155], v5 offset:384
  ds_read_b128 v[156:159], v5 offset:448
  ds_read_b128 v[160:163], v5 offset:512
  ds_read_b128 v[164:167], v5 offset:576
  ds_read_b128 v[168:171], v5 offset:640
  ds_read_b128 v[172:175], v5 offset:704
  ds_read_b128 v[176:179], v5 offset:768
  ds_read_b128 v[180:183], v5 offset:832
  ds_read_b128 v[184:187], v5 offset:896
  ds_read_b128 v[188:191], v5 offset:960
L_noqk_85:
  ds_read_b64_tr_b16 v[204:205], v7 offset:33792
  ds_read_b64_tr_b16 v[206:207], v7 offset:50688
  ds_read_b64_tr_b16 v[220:221], v7 offset:33824
  ds_read_b64_tr_b16 v[222:223], v7 offset:50720
  ds_read_b64_tr_b16 v[236:237], v7 offset:33856
  ds_read_b64_tr_b16 v[238:239], v7 offset:50752
  ds_read_b64_tr_b16 v[252:253], v7 offset:33888
  ds_read_b64_tr_b16 v[254:255], v7 offset:50784
  s_waitcnt vmcnt(0)
  v_bitop3_b32 v31, v32, v33, v9 bitop3:0x7e
  v_bitop3_b32 v31, v31, v34, v9 bitop3:0xf6
  v_bitop3_b32 v31, v31, v35, v9 bitop3:0xf6
  v_bitop3_b32 v31, v31, v36, v9 bitop3:0xf6
  v_bitop3_b32 v31, v31, v37, v9 bitop3:0xf6
  v_bitop3_b32 v31, v31, v38, v9 bitop3:0xf6
  v_bitop3_b32 v31, v31, v39, v9 bitop3:0xf6
  v_bitop3_b32 v31, v31, v40, v9 bitop3:0xf6
  v_bitop3_b32 v31, v31, v41, v9 bitop3:0xf6
  v_bitop3_b32 v31, v31, v42, v9 bitop3:0xf6
  v_bitop3_b32 v31, v31, v43, v9 bitop3:0xf6
  v_bitop3_b32 v31, v31, v44, v9 bitop3:0xf6
  v_bitop3_b32 v31, v31, v45, v9 bitop3:0xf6
  v_bitop3_b32 v31, v31, v46, v9 bitop3:0xf6
  v_bitop3_b32 v31, v31, v47, v9 bitop3:0xf6
  v_and_b32 v31, 0xff, v31
  v_cmp_ne_u32 vcc, 0, v31
  s_cbranch_vccz L_qfast_86
L_pollQ_87:
  buffer_load_dwordx4 v[32:35], v12, s[48:51], 0 offen offset:0 sc1
  buffer_load_dwordx4 v[36:39], v12, s[48:51], 0 offen offset:1024 sc1
  buffer_load_dwordx4 v[40:43], v12, s[48:51], 0 offen offset:2048 sc1
  buffer_load_dwordx4 v[44:47], v12, s[48:51], 0 offen offset:3072 sc1
  s_waitcnt vmcnt(0)
  v_bitop3_b32 v31, v32, v33, v9 bitop3:0x7e
  v_bitop3_b32 v31, v31, v34, v9 bitop3:0xf6
  v_bitop3_b32 v31, v31, v35, v9 bitop3:0xf6
  v_bitop3_b32 v31, v31, v36, v9 bitop3:0xf6
  v_bitop3_b32 v31, v31, v37, v9 bitop3:0xf6
  v_bitop3_b32 v31, v31, v38, v9 bitop3:0xf6
  v_bitop3_b32 v31, v31, v39, v9 bitop3:0xf6
  v_bitop3_b32 v31, v31, v40, v9 bitop3:0xf6
  v_bitop3_b32 v31, v31, v41, v9 bitop3:0xf6
  v_bitop3_b32 v31, v31, v42, v9 bitop3:0xf6
  v_bitop3_b32 v31, v31, v43, v9 bitop3:0xf6
  v_bitop3_b32 v31, v31, v44, v9 bitop3:0xf6
  v_bitop3_b32 v31, v31, v45, v9 bitop3:0xf6
  v_bitop3_b32 v31, v31, v46, v9 bitop3:0xf6
  v_bitop3_b32 v31, v31, v47, v9 bitop3:0xf6
  v_and_b32 v31, 0xff, v31
  v_cmp_ne_u32 vcc, 0, v31
  s_add_u32 s62, s62, 1
  s_cbranch_vccz L_pd_88
  s_cmp_lt_u32 s62, 400000
  s_cbranch_scc1 L_pollQ_87
L_pd_88:
L_qfast_86:
L_pA0_65:
  v_perm_b32 v32, v33, v32, s16
  v_perm_b32 v33, v35, v34, s16
  ds_write_b64 v13, v[32:33] offset:0
  v_perm_b32 v36, v37, v36, s16
  v_perm_b32 v37, v39, v38, s16
  ds_write_b64 v13, v[36:37] offset:512
  v_perm_b32 v40, v41, v40, s16
  v_perm_b32 v41, v43, v42, s16
  ds_write_b64 v13, v[40:41] offset:1056
  v_perm_b32 v44, v45, v44, s16
  v_perm_b32 v45, v47, v46, s16
  ds_write_b64 v13, v[44:45] offset:1568
  s_mul_i32 s63, s69, 552960
  s_lshl_b32 s64, s68, 7
  s_add_u32 s63, s63, s64
  s_mul_i32 s64, s56, 27648
  s_add_u32 s63, s63, s64
  s_lshl_b32 s64, s56, 10
  s_add_u32 s64, s64, 0
  s_cmp_lt_u32 s68, 27
  s_cselect_b32 s38, 2211840, 0
  s_lshl_b32 s27, s68, 6
  s_and_b32 s76, s56, 3
  s_lshl_b32 s65, s76, 4
  s_add_u32 s27, s27, s65
  s_mul_i32 s27, s27, 1280
  s_mul_i32 s65, s69, 320
  s_add_u32 s27, s27, s65
  s_mul_i32 s76, s76, 5120
  s_add_u32 s76, s76, 20480
  s_cmp_lt_u32 s68, 27
  s_cselect_b32 s42, 2211840, 0
  s_cmp_lt_u32 s56, 4
  s_cselect_b32 s65, 0, 3072
  s_add_u32 s76, s76, s65
  s_waitcnt lgkmcnt(0)
  s_cbranch_execz L_dryAx_72
  s_barrier
L_pA1_66:
  ds_read_b128 v[64:67], v8 offset:0
  ds_read_b128 v[68:71], v8 offset:64
  ds_read_b128 v[72:75], v8 offset:128
  ds_read_b128 v[76:79], v8 offset:192
  ds_read_b128 v[80:83], v8 offset:256
  ds_read_b128 v[84:87], v8 offset:320
  ds_read_b128 v[88:91], v8 offset:384
  ds_read_b128 v[92:95], v8 offset:448
  ds_read_b128 v[96:99], v8 offset:512
  ds_read_b128 v[100:103], v8 offset:576
  ds_read_b128 v[104:107], v8 offset:640
  ds_read_b128 v[108:111], v8 offset:704
  ds_read_b128 v[112:115], v8 offset:768
  ds_read_b128 v[116:119], v8 offset:832
  ds_read_b128 v[120:123], v8 offset:896
  ds_read_b128 v[124:127], v8 offset:960
  s_waitcnt lgkmcnt(15)
  v_mfma_f32_16x16x32_bf16 v[24:27], v[128:131], v[64:67], 0
  s_cbranch_execz L_dryAx_72
  s_waitcnt lgkmcnt(14)
  v_mfma_f32_16x16x32_bf16 v[24:27], v[132:135], v[68:71], v[24:27]
  s_mov_b32 m0, s64
  s_add_u32 s64, s64, 8192
  buffer_load_dwordx4 v48, s[36:39], s63 offen  lds
  s_add_u32 s63, s63, 221184
  s_waitcnt lgkmcnt(13)
  v_mfma_f32_16x16x32_bf16 v[24:27], v[136:139], v[72:75], v[24:27]
  s_waitcnt lgkmcnt(12)
  v_mfma_f32_16x16x32_bf16 v[24:27], v[140:143], v[76:79], v[24:27]
  s_mov_b32 m0, s64
  s_add_u32 s64, s64, 8192
  buffer_load_dwordx4 v48, s[36:39], s63 offen  lds
  s_add_u32 s63, s63, 221184
  s_waitcnt lgkmcnt(11)
  v_mfma_f32_16x16x32_bf16 v[24:27], v[144:147], v[80:83], v[24:27]
  s_waitcnt lgkmcnt(10)
  v_mfma_f32_16x16x32_bf16 v[24:27], v[148:151], v[84:87], v[24:27]
  s_cmp_lt_u32 s56, 4
  s_cbranch_scc0 L_w1c_89
  s_mov_b32 m0, s64
  s_nop 0
  buffer_load_dwordx4 v48, s[36:39], s63 offen  lds
L_w1c_89:
  s_waitcnt lgkmcnt(9)
  v_mfma_f32_16x16x32_bf16 v[24:27], v[152:155], v[88:91], v[24:27]
  s_waitcnt lgkmcnt(8)
  v_mfma_f32_16x16x32_bf16 v[24:27], v[156:159], v[92:95], v[24:27]
  s_waitcnt lgkmcnt(7)
  v_mfma_f32_16x16x32_bf16 v[24:27], v[160:163], v[96:99], v[24:27]
  s_cmp_lt_u32 s56, 4
  s_cbranch_scc0 L_w2a_90
  s_mov_b32 m0, s76
  s_add_u32 s76, s76, 1024
  buffer_load_dwordx4 v49, s[40:43], s27 offen  lds
  s_branch L_w2b_91
L_w2a_90:
  s_mov_b32 m0, s76
  s_add_u32 s76, s76, 1024
  buffer_load_dwordx4 v52, s[40:43], s27 offen  lds
L_w2b_91:
  s_waitcnt lgkmcnt(6)
  v_mfma_f32_16x16x32_bf16 v[24:27], v[164:167], v[100:103], v[24:27]
  s_waitcnt lgkmcnt(5)
  v_mfma_f32_16x16x32_bf16 v[24:27], v[168:171], v[104:107], v[24:27]
  s_cmp_lt_u32 s56, 4
  s_cbranch_scc0 L_w2a_92
  s_mov_b32 m0, s76
  s_add_u32 s76, s76, 1024
  buffer_load_dwordx4 v50, s[40:43], s27 offen  lds
  s_branch L_w2b_93
L_w2a_92:
  s_mov_b32 m0, s76
  s_add_u32 s76, s76, 1024
  buffer_load_dwordx4 v53, s[40:43], s27 offen  lds
L_w2b_93:
  s_waitcnt lgkmcnt(4)
  v_mfma_f32_16x16x32_bf16 v[24:27], v[172:175], v[108:111], v[24:27]
  s_waitcnt lgkmcnt(3)
  v_mfma_f32_16x16x32_bf16 v[24:27], v[176:179], v[112:115], v[24:27]
  s_cmp_lt_u32 s56, 4
  s_cbranch_scc0 L_w2a_94
  s_mov_b32 m0, s76
  s_add_u32 s76, s76, 1024
  buffer_load_dwordx4 v51, s[40:43], s27 offen  lds
  s_branch L_w2b_95
L_w2a_94:
L_w2b_95:
L_pA2_67:
  s_waitcnt lgkmcnt(2)
  v_mfma_f32_16x16x32_bf16 v[24:27], v[180:183], v[116:119], v[24:27]
  s_waitcnt lgkmcnt(1)
  v_mfma_f32_16x16x32_bf16 v[24:27], v[184:187], v[120:123], v[24:27]
  s_waitcnt lgkmcnt(0)
  v_mfma_f32_16x16x32_bf16 v[24:27], v[188:191], v[124:127], v[24:27]
  s_nop 7
  v_max3_f32 v28, v24, v25, v26
  v_max_f32 v28, v28, v27
  v_mov_b32 v29, v28
  s_nop 1
  v_permlane16_swap_b32 v28, v29
  v_max_f32 v28, v28, v29
  v_mov_b32 v29, v28
  s_nop 1
  v_permlane32_swap_b32 v28, v29
  v_max_f32 v28, v28, v29
  ds_write_b32 v14, v28
  s_waitcnt lgkmcnt(0)
  s_cbranch_execz L_dryAx_72
  s_barrier
L_pA3_68:
  ds_read_b128 v[32:35], v15
  ds_read_b128 v[36:39], v15 offset:16
  s_waitcnt lgkmcnt(0)
  v_max3_f32 v28, v32, v33, v34
  v_max3_f32 v29, v35, v36, v37
  v_max3_f32 v28, v28, v38, v39
  v_max_f32 v28, v28, v29
  v_sub_f32 v24, v24, v28
  v_sub_f32 v25, v25, v28
  v_sub_f32 v26, v26, v28
  v_sub_f32 v27, v27, v28
  s_cmp_eq_u32 s56, 1
  s_cbranch_scc0 L_nomax_96
  v_mov_b32 v32, v28
  v_mov_b32 v33, s60
  s_mov_b64 exec, s[6:7]
  s_cbranch_execz L_skipmem_14
  buffer_store_dwordx2 v[32:33], v19, s[48:51], 0 offen sc1
L_skipmem_14:
  s_mov_b64 exec, s[4:5]
L_nomax_96:
  v_exp_f32 v24, v24
  v_exp_f32 v25, v25
  v_exp_f32 v26, v26
  v_exp_f32 v27, v27
  v_cvt_pk_bf16_f32 v30, v24, v25
  v_cvt_pk_bf16_f32 v31, v26, v27
  ds_write_b64 v16, v[30:31]
  v_lshlrev_b32 v24, 16, v30
  v_and_b32 v25, 0xffff0000, v30
  v_lshlrev_b32 v26, 16, v31
  v_and_b32 v27, 0xffff0000, v31
  v_add_f32 v40, v24, v25
  v_add_f32 v26, v26, v27
  v_add_f32 v40, v40, v26
  v_mov_b32 v29, v40
  s_nop 1
  v_permlane16_swap_b32 v40, v29
  v_add_f32 v40, v40, v29
  v_mov_b32 v29, v40
  s_nop 1
  v_permlane32_swap_b32 v40, v29
  v_add_f32 v40, v40, v29
  ds_write_b32 v14, v40 offset:512
  s_waitcnt lgkmcnt(0)
  s_cbranch_execz L_dryAx_72
  s_barrier
L_pA4_69:
  ds_read_b128 v[64:67], v17
  ds_read_b128 v[32:35], v15 offset:512
  ds_read_b128 v[36:39], v15 offset:528
  ds_read_b128 v[68:71], v17 offset:1024
  ds_read_b128 v[72:75], v17 offset:2048
  ds_read_b128 v[76:79], v17 offset:3072
  s_waitcnt lgkmcnt(5)
  v_mfma_f32_16x16x32_bf16 v[80:83], v[192:195], v[64:67], 0
  v_mfma_f32_16x16x32_bf16 v[84:87], v[208:211], v[64:67], 0
  v_mfma_f32_16x16x32_bf16 v[88:91], v[224:227], v[64:67], 0
  v_mfma_f32_16x16x32_bf16 v[92:95], v[240:243], v[64:67], 0
  s_cmp_eq_u32 s56, 0
  s_cbranch_scc0 L_nostats_97
  s_waitcnt lgkmcnt(3)
  v_add_f32 v32, v32, v33
  v_add_f32 v34, v34, v35
  v_add_f32 v36, v36, v37
  v_add_f32 v38, v38, v39
  v_add_f32 v32, v32, v34
  v_add_f32 v36, v36, v38
  v_add_f32 v32, v32, v36
  v_mov_b32 v33, s60
  s_mov_b32 s65, 16384
  s_mov_b64 exec, s[6:7]
  s_cbranch_execz L_skipmem_15
  buffer_store_dwordx2 v[32:33], v19, s[48:51], s65 offen sc1
L_skipmem_15:
  s_mov_b64 exec, s[4:5]
L_nostats_97:
  s_cbranch_execz L_dryAx_72
L_pA5_70:
  s_waitcnt lgkmcnt(2)
  v_mfma_f32_16x16x32_bf16 v[80:83], v[196:199], v[68:71], v[80:83]
  v_mfma_f32_16x16x32_bf16 v[84:87], v[212:215], v[68:71], v[84:87]
  v_mfma_f32_16x16x32_bf16 v[88:91], v[228:231], v[68:71], v[88:91]
  v_mfma_f32_16x16x32_bf16 v[92:95], v[244:247], v[68:71], v[92:95]
  s_waitcnt lgkmcnt(1)
  v_mfma_f32_16x16x32_bf16 v[80:83], v[200:203], v[72:75], v[80:83]
  v_mfma_f32_16x16x32_bf16 v[84:87], v[216:219], v[72:75], v[84:87]
  v_mfma_f32_16x16x32_bf16 v[88:91], v[232:235], v[72:75], v[88:91]
  v_mfma_f32_16x16x32_bf16 v[92:95], v[248:251], v[72:75], v[92:95]
  s_waitcnt lgkmcnt(0)
  v_mfma_f32_16x16x32_bf16 v[80:83], v[204:207], v[76:79], v[80:83]
  v_mfma_f32_16x16x32_bf16 v[84:87], v[220:223], v[76:79], v[84:87]
  v_mfma_f32_16x16x32_bf16 v[88:91], v[236:239], v[76:79], v[88:91]
  v_mfma_f32_16x16x32_bf16 v[92:95], v[252:255], v[76:79], v[92:95]
  s_nop 4
  v_perm_b32 v40, v81, v80, s16
  v_perm_b32 v41, v83, v82, s16
  v_perm_b32 v42, v85, v84, s16
  v_perm_b32 v43, v87, v86, s16
  v_perm_b32 v44, v89, v88, s16
  v_perm_b32 v45, v91, v90, s16
  v_perm_b32 v46, v93, v92, s16
  v_perm_b32 v47, v95, v94, s16
  v_permlane16_swap_b32 v40, v42
  v_permlane16_swap_b32 v41, v43
  v_permlane16_swap_b32 v44, v46
  v_permlane16_swap_b32 v45, v47
  s_cbranch_execz L_dryAx_72
L_pA6_71:
  v_add_u32 v40, s8, v40
  v_add_u32 v41, s8, v41
  v_add_u32 v42, s8, v42
  v_add_u32 v43, s8, v43
  v_add_u32 v44, s8, v44
  v_add_u32 v45, s8, v45
  v_add_u32 v46, s8, v46
  v_add_u32 v47, s8, v47
  v_bfi_b32 v40, s8, v0, v40
  v_bfi_b32 v41, s8, v20, v41
  v_bfi_b32 v42, s8, v21, v42
  v_bfi_b32 v43, s8, v22, v43
  v_bfi_b32 v44, s8, v23, v44
  v_bfi_b32 v45, s8, v62, v45
  v_bfi_b32 v46, s8, v63, v46
  v_bfi_b32 v47, s8, v10, v47
  v_mov_b32 v24, v40
  v_mov_b32 v25, v41
  v_mov_b32 v26, v42
  v_mov_b32 v27, v43
  v_mov_b32_dpp v40, v44 row_ror:8 row_mask:0xf bank_mask:0xc
  v_mov_b32_dpp v41, v45 row_ror:8 row_mask:0xf bank_mask:0xc
  v_mov_b32_dpp v42, v46 row_ror:8 row_mask:0xf bank_mask:0xc
  v_mov_b32_dpp v43, v47 row_ror:8 row_mask:0xf bank_mask:0xc
  s_cbranch_execz L_skipmem_16
  buffer_store_dwordx4 v[40:43], v18, s[48:51], 0 offen sc1
L_skipmem_16:
  v_mov_b32_dpp v44, v24 row_ror:8 row_mask:0xf bank_mask:0x3
  v_mov_b32_dpp v45, v25 row_ror:8 row_mask:0xf bank_mask:0x3
  v_mov_b32_dpp v46, v26 row_ror:8 row_mask:0xf bank_mask:0x3
  v_mov_b32_dpp v47, v27 row_ror:8 row_mask:0xf bank_mask:0x3
  s_mov_b32 s65, 524288
  s_cbranch_execz L_skipmem_17
  buffer_store_dwordx4 v[44:47], v18, s[48:51], s65 offen sc1
L_skipmem_17:
  s_cbranch_execz L_dryAx_72
  s_cmp_lt_u32 s68, 27
  s_cbranch_scc0 L_noffn_98
  s_mul_i32 s63, s69, 320
  s_add_u32 s63, s63, 157184
  v_and_b32 v10, 1, v2
  v_mul_u32_u24 v54, 1280, v10
  v_lshl_add_u32 v54, v3, 4, v54
  v_add_u32 v54, s63, v54
  v_lshrrev_b32 v10, 2, v2
  v_lshl_add_u32 v11, v3, 3, v10
  v_lshlrev_b32 v55, 7, v11
  v_mul_u32_u24 v59, 320, v11
  v_lshrrev_b32 v10, 1, v10
  v_and_b32 v11, 1, v3
  v_lshl_or_b32 v10, v11, 1, v10
  v_lshlrev_b32 v10, 1, v10
  v_bfe_u32 v11, v2, 1, 1
  s_and_b32 s63, s56, 3
  s_lshl_b32 s63, s63, 1
  v_or_b32 v11, s63, v11
  v_xor_b32 v11, v11, v10
  v_lshl_add_u32 v55, v11, 4, v55
  v_and_b32 v10, 1, v2
  v_lshl_add_u32 v55, v10, 3, v55
  s_lshl_b32 s63, s68, 2
  s_add_u32 s63, s63, s69
  s_lshl_b32 s63, s63, 9
  s_lshl_b32 s64, s56, 7
  s_add_u32 s63, s63, s64
  s_add_u32 s63, s63, 720896
  v_lshlrev_b32 v56, 6, v10
  v_lshl_add_u32 v56, v3, 4, v56
  v_add_u32 v56, s63, v56
  v_mul_u32_u24 v58, 160, v10
  v_lshl_add_u32 v58, v3, 4, v58
  v_add_u32 v58, 159744, v58
  v_mul_u32_u24 v57, 160, v3
  v_lshl_add_u32 v57, v2, 3, v57
  v_add_u32 v57, 159744, v57
  s_mul_i32 s63, s69, 10
  s_add_u32 s63, s63, s56
  s_lshl_b32 s63, s63, 6
  s_add_u32 s63, s63, s68
  s_add_u32 s63, s63, 32
  s_lshl_b32 s63, s63, 7
  s_add_u32 s63, s63, 917504
  v_lshlrev_b32 v60, 6, v10
  v_lshl_add_u32 v60, v3, 4, v60
  v_add_u32 v60, s63, v60
  v_and_b32 v10, 3, v2
  v_lshl_add_u32 v59, v10, 3, v59
  s_lshl_b32 s63, s56, 5
  s_add_u32 s63, s63, 20480
  v_add_u32 v59, s63, v59
  s_lshl_b32 s63, s68, 11
  s_add_u32 s63, s63, 720896
  v_lshrrev_b32 v10, 2, v2
  v_lshlrev_b32 v61, 7, v10
  v_lshl_add_u32 v61, v3, 6, v61
  v_and_b32 v10, 3, v2
  v_lshl_add_u32 v61, v10, 4, v61
  v_add_u32 v61, s63, v61
  s_waitcnt vmcnt(4)
  s_barrier
  s_cmp_lt_u32 s56, 4
  s_cbranch_scc0 L_noffn1_99
  s_lshl_b32 s63, s68, 6
  s_lshl_b32 s64, s56, 4
  s_add_u32 s63, s63, s64
  s_mul_i32 s63, s63, 1280
  s_mul_i32 s64, s69, 320
  s_add_u32 s63, s63, s64
  s_mul_i32 s64, s56, 5120
  s_add_u32 s64, s64, 20480
  ds_read_b128 v[64:67], v54 offset:0
  ds_read_b64_tr_b16 v[84:85], v55 offset:0
  ds_read_b64_tr_b16 v[86:87], v55 offset:512
  ds_read_b128 v[68:71], v54 offset:64
  ds_read_b64_tr_b16 v[88:89], v55 offset:4096
  ds_read_b64_tr_b16 v[90:91], v55 offset:4608
  ds_read_b128 v[72:75], v54 offset:128
  ds_read_b64_tr_b16 v[92:93], v55 offset:8192
  ds_read_b64_tr_b16 v[94:95], v55 offset:8704
  ds_read_b128 v[76:79], v54 offset:192
  ds_read_b64_tr_b16 v[96:97], v55 offset:12288
  ds_read_b64_tr_b16 v[98:99], v55 offset:12800
  ds_read_b128 v[80:83], v54 offset:256
  ds_read_b64_tr_b16 v[100:101], v55 offset:16384
  ds_read_b64_tr_b16 v[102:103], v55 offset:16896
  s_mov_b32 s63, 65536
  s_waitcnt lgkmcnt(12)
  v_mfma_f32_16x16x32_bf16 v[104:107], v[84:87], v[64:67], 0
  s_waitcnt lgkmcnt(9)
  v_mfma_f32_16x16x32_bf16 v[104:107], v[88:91], v[68:71], v[104:107]
  s_waitcnt lgkmcnt(6)
  v_mfma_f32_16x16x32_bf16 v[104:107], v[92:95], v[72:75], v[104:107]
  s_waitcnt lgkmcnt(3)
  v_mfma_f32_16x16x32_bf16 v[104:107], v[96:99], v[76:79], v[104:107]
  s_waitcnt lgkmcnt(0)
  v_mfma_f32_16x16x32_bf16 v[104:107], v[100:103], v[80:83], v[104:107]
  s_nop 7
  v_and_or_b32 v104, v104, s77, v9
  v_and_or_b32 v105, v105, s77, v9
  v_and_or_b32 v106, v106, s77, v9
  v_and_or_b32 v107, v107, s77, v9
  s_mov_b64 exec, s[70:71]
  buffer_store_dwordx4 v[104:107], v56, s[48:51], 0 offen
  buffer_store_dwordx4 v[104:107], v56, s[48:51], s63 offen sc1
  s_mov_b64 exec, s[4:5]
L_noffn1_99:
  s_cmp_eq_u32 s56, 4
  s_cbranch_scc0 L_noh_100
  s_mov_b64 exec, s[72:73]
  s_mov_b32 s63, 0
  s_mov_b32 s79, 0
L_pollH_101:
  buffer_load_dwordx4 v[64:67], v61, s[48:51], s63 offen offset:0 sc1
  buffer_load_dwordx4 v[68:71], v61, s[48:51], s63 offen offset:512 sc1
  buffer_load_dwordx4 v[72:75], v61, s[48:51], s63 offen offset:1024 sc1
  buffer_load_dwordx4 v[76:79], v61, s[48:51], s63 offen offset:1536 sc1
  s_add_u32 s79, s79, 1
  s_cmp_gt_u32 s79, 6
  s_cselect_b32 s64, 65536, 0
  s_xor_b32 s63, s63, s64
  s_waitcnt vmcnt(0)
  v_xor_b32 v64, v64, v9
  v_xor_b32 v65, v65, v9
  v_xor_b32 v66, v66, v9
  v_xor_b32 v67, v67, v9
  v_xor_b32 v68, v68, v9
  v_xor_b32 v69, v69, v9
  v_xor_b32 v70, v70, v9
  v_xor_b32 v71, v71, v9
  v_xor_b32 v72, v72, v9
  v_xor_b32 v73, v73, v9
  v_xor_b32 v74, v74, v9
  v_xor_b32 v75, v75, v9
  v_xor_b32 v76, v76, v9
  v_xor_b32 v77, v77, v9
  v_xor_b32 v78, v78, v9
  v_xor_b32 v79, v79, v9
  v_or3_b32 v80, v64, v65, v66
  v_or3_b32 v80, v80, v67, v68
  v_or3_b32 v80, v80, v69, v70
  v_or3_b32 v80, v80, v71, v72
  v_or3_b32 v80, v80, v73, v74
  v_or3_b32 v80, v80, v75, v76
  v_or3_b32 v80, v80, v77, v78
  v_or_b32 v80, v80, v79
  v_and_b32 v80, 0xff, v80
  v_cmp_ne_u32 vcc, 0, v80
  s_add_u32 s62, s62, 1
  s_cbranch_vccz L_pd_102
  s_cmp_lt_u32 s62, 400000
  s_cbranch_scc1 L_pollH_101
L_pd_102:
  v_add_f32 v64, v64, v68
  v_add_f32 v72, v72, v76
  v_add_f32 v65, v65, v69
  v_add_f32 v73, v73, v77
  v_add_f32 v66, v66, v70
  v_add_f32 v74, v74, v78
  v_add_f32 v67, v67, v71
  v_add_f32 v75, v75, v79
  v_add_f32 v64, v64, v72
  v_add_f32 v65, v65, v73
  v_add_f32 v66, v66, v74
  v_add_f32 v67, v67, v75
  v_cvt_pk_bf16_f32 v64, v64, v64
  v_and_b32 v64, 0xffff0000, v64
  v_cvt_pk_bf16_f32 v65, v65, v65
  v_and_b32 v65, 0xffff0000, v65
  v_cvt_pk_bf16_f32 v66, v66, v66
  v_and_b32 v66, 0xffff0000, v66
  v_cvt_pk_bf16_f32 v67, v67, v67
  v_and_b32 v67, 0xffff0000, v67
  v_mul_f32 v80, 0xbfb8aa3b, v64
  v_mul_f32 v81, 0xbfb8aa3b, v65
  v_mul_f32 v82, 0xbfb8aa3b, v66
  v_mul_f32 v83, 0xbfb8aa3b, v67
  v_exp_f32 v80, v80
  v_exp_f32 v81, v81
  v_exp_f32 v82, v82
  v_exp_f32 v83, v83
  v_add_f32 v80, 1.0, v80
  v_add_f32 v81, 1.0, v81
  v_add_f32 v82, 1.0, v82
  v_add_f32 v83, 1.0, v83
  v_rcp_f32 v80, v80
  v_rcp_f32 v81, v81
  v_rcp_f32 v82, v82
  v_rcp_f32 v83, v83
  v_mul_f32 v64, v64, v80
  v_mul_f32 v65, v65, v81
  v_mul_f32 v66, v66, v82
  v_mul_f32 v67, v67, v83
  v_cvt_pk_bf16_f32 v64, v64, v65
  v_cvt_pk_bf16_f32 v65, v66, v67
  ds_write_b64 v57, v[64:65]
  s_mov_b64 exec, s[4:5]
L_noh_100:
  s_waitcnt vmcnt(0) lgkmcnt(0)
  s_barrier
  ds_read_b128 v[64:67], v58 offset:0
  ds_read_b128 v[68:71], v58 offset:64
  ds_read_b64_tr_b16 v[112:113], v59 offset:0
  ds_read_b64_tr_b16 v[114:115], v59 offset:1280
  ds_read_b64_tr_b16 v[116:117], v59 offset:10240
  ds_read_b64_tr_b16 v[118:119], v59 offset:11520
  ds_read_b64_tr_b16 v[120:121], v59 offset:256
  ds_read_b64_tr_b16 v[122:123], v59 offset:1536
  ds_read_b64_tr_b16 v[124:125], v59 offset:10496
  ds_read_b64_tr_b16 v[126:127], v59 offset:11776
  s_waitcnt lgkmcnt(0)
  v_mfma_f32_16x16x32_bf16 v[72:75], v[112:115], v[64:67], 0
  v_mfma_f32_16x16x32_bf16 v[76:79], v[120:123], v[64:67], 0
  v_mfma_f32_16x16x32_bf16 v[72:75], v[116:119], v[68:71], v[72:75]
  v_mfma_f32_16x16x32_bf16 v[76:79], v[124:127], v[68:71], v[76:79]
  s_nop 6
  v_and_or_b32 v72, v72, s77, v9
  v_and_or_b32 v73, v73, s77, v9
  v_and_or_b32 v74, v74, s77, v9
  v_and_or_b32 v75, v75, s77, v9
  v_and_or_b32 v76, v76, s77, v9
  v_and_or_b32 v77, v77, s77, v9
  v_and_or_b32 v78, v78, s77, v9
  v_and_or_b32 v79, v79, s77, v9
  s_mov_b64 exec, s[70:71]
  buffer_store_dwordx4 v[72:75], v60, s[48:51], 0 offen sc1
  s_mov_b64 exec, s[4:5]
  s_cmp_lt_u32 s56, 2
  s_cbranch_scc0 L_no2t_103
  s_mov_b32 s63, 65536
  s_mov_b64 exec, s[70:71]
  buffer_store_dwordx4 v[76:79], v60, s[48:51], s63 offen sc1
  s_mov_b64 exec, s[4:5]
L_no2t_103:
L_noffn_98:
  s_endpgm
L_end:
  s_endpgm

.section .rodata,"a"
.p2align 6
.amdhsa_kernel recurrent_scan__compressed_kv_cla__dense_activation_silu__decode_kernel
  .amdhsa_next_free_vgpr 256
  .amdhsa_next_free_sgpr 102
  .amdhsa_accum_offset 256
  .amdhsa_group_segment_fixed_size 0
  .amdhsa_kernarg_size 96
  .amdhsa_user_sgpr_count 2
  .amdhsa_user_sgpr_kernarg_segment_ptr 1
  .amdhsa_system_sgpr_workgroup_id_x 1
.end_amdhsa_kernel
```
